```python
import torch

def _softmax(x, axis=-1):
    return torch.softmax(x, dim=axis)

def _gelu(x):
    return torch.nn.functional.gelu(x, approximate='tanh')

def _silu(x):
    return torch.nn.functional.silu(x)

def _sigmoid(x):
    return torch.sigmoid(x)

def _layernorm(x, axis=-1, eps=1e-05):
    m = x.mean(dim=axis, keepdim=True)
    v = x.var(dim=axis, keepdim=True, unbiased=False)
    return (x - m) / torch.sqrt(v + eps)

def _scatter_add(tgt, idx, src, axis=0):
    return tgt.clone().index_add_(axis, idx, src)

def _segment_sum(src, seg, n):
    out = torch.zeros((n,) + src.shape[1:], dtype=src.dtype)
    return out.index_add_(0, seg, src)

def _pad(x, pw):
    flat = tuple((v for pair in reversed(pw) for v in pair))
    return torch.nn.functional.pad(x, flat)
kernel_name = 'adaLN_cond__ssm_conv_s4__dense_activation_relu__prompt'

def setup_inputs():

    _w = lambda a: (lambda t: t.to(torch.bfloat16) if t.is_floating_point() else t)(torch.as_tensor(a))

    def _A_setup():
        B, L, D, N = (1, 2048, 640, 128)
        A_re = -(lambda _x: torch.exp(torch.as_tensor(_x)))((lambda *s: torch.randn(*s, dtype=torch.bfloat16) * 3.2)(D, N))
        A_im = torch.pi * (lambda *s: torch.randn(*s, dtype=torch.bfloat16) * 0.1)(D, N)
        B_re = (lambda *s: torch.randn(*s, dtype=torch.bfloat16) * 0.2)(D, N)
        B_im = (lambda *s: torch.randn(*s, dtype=torch.bfloat16) * 0.2)(D, N)
        C_re = (lambda *s: torch.randn(*s, dtype=torch.bfloat16) * 0.2)(D, N)
        C_im = (lambda *s: torch.randn(*s, dtype=torch.bfloat16) * 0.2)(D, N)
        log_dt = (lambda *s: torch.randn(*s, dtype=torch.bfloat16) * 0.1)(D) * 0.5 - 4.0
        Dskip = (lambda *s: torch.randn(*s, dtype=torch.bfloat16) * 0.2)(D)
        return {'u': _w((lambda *s: torch.randn(*s, dtype=torch.bfloat16) * 0.05)(B, L, D)), 'A_re': _w(A_re), 'A_im': _w(A_im), 'B_re': _w(B_re), 'B_im': _w(B_im), 'C_re': _w(C_re), 'C_im': _w(C_im), 'log_dt': _w(log_dt), 'Dskip': _w(Dskip)}
    _A_in = _A_setup()

    def _B_setup():
        B, S, D, Dff = (1, 2048, 640, 1728)
        return {'x': _w((lambda *s: torch.randn(*s, dtype=torch.bfloat16) * 0.05)(B, S, D)), 'w1': _w((lambda *s: torch.randn(*s, dtype=torch.bfloat16) * 0.05)(D, Dff)), 'w2': _w((lambda *s: torch.randn(*s, dtype=torch.bfloat16) * 0.05)(Dff, D))}
    _B_in = _B_setup()
    return {'A_u': _A_in['u'], 'A_A_re': _A_in['A_re'], 'A_A_im': _A_in['A_im'], 'A_B_re': _A_in['B_re'], 'A_B_im': _A_in['B_im'], 'A_C_re': _A_in['C_re'], 'A_C_im': _A_in['C_im'], 'A_log_dt': _A_in['log_dt'], 'A_Dskip': _A_in['Dskip'], 'B_x': _B_in['x'], 'B_w1': _B_in['w1'], 'B_w2': _B_in['w2'], 'c': _w((lambda *s: torch.randn(*s, dtype=torch.bfloat16) * 0.1)(1, 640) * 8.0), 'w_mod': _w((lambda *s: torch.randn(*s, dtype=torch.bfloat16) * 0.1)(640, 6 * 640) * 640 ** (-0.5) * 8.0)}

def reference(A_u, A_A_re, A_A_im, A_B_re, A_B_im, A_C_re, A_C_im, A_log_dt, A_Dskip, B_x, B_w1, B_w2, c, w_mod):

    def _A_ref(u, A_re, A_im, B_re, B_im, C_re, C_im, log_dt, Dskip):
        Bsz, L, D = u.shape
        dt = torch.exp(log_dt)[:, None]
        A = A_re + 1j * A_im
        Bc = B_re + 1j * B_im
        Cc = C_re + 1j * C_im
        logdA = dt * A
        dB = dt * Bc
        l = (lambda x, dt: x.to(dt))(torch.arange(L), A_re.dtype)
        P = torch.exp(logdA[:, :, None] * l[None, None, :])
        K = torch.einsum('dn,dnl,dn->dl', Cc, P, dB).real
        L2 = 2 * L
        Kp = _pad(K, ((0, 0), (0, L)))
        up = (lambda x, *d: x.permute(*d))(u, 0, 2, 1)
        up = _pad(up, ((0, 0), (0, 0), (0, L)))
        Kf = (lambda x, axes=(-2, -1): torch.fft.rfft2(x.float(), dim=axes))(Kp[:, None, :], axes=(-2, -1))
        Uf = (lambda x, axes=(-2, -1): torch.fft.rfft2(x.float(), dim=axes))(up[:, :, None, :], axes=(-2, -1))
        Yf = Uf * Kf[None, :, :, :]
        y = (lambda x, s, axes=(-2, -1): torch.fft.irfft2(x, s=s, dim=axes).to(torch.bfloat16))(Yf, (1, L2), axes=(-2, -1))[:, :, 0, :L]
        y = (lambda x, *d: x.permute(*d))(y, 0, 2, 1) + u * Dskip[None, None, :]
        return y

    def _B_ref(x, w1, w2):
        h = torch.einsum('bsd,df->bsf', x, w1)
        zero = torch.zeros_like(h)
        h = torch.maximum(h, zero)
        return torch.einsum('bsf,fd->bsd', h, w2)
    x = A_u
    mod = (_silu(c) @ w_mod).reshape(c.shape[0], 6, 1, -1)
    sa, ca, ga, sb, cb, gb = (mod[:, 0].clone(), mod[:, 1].clone(), mod[:, 2].clone(), mod[:, 3].clone(), mod[:, 4].clone(), mod[:, 5].clone())
    h = _layernorm(x, axis=-1) * (1 + ca) + sa
    x = x + ga * _A_ref(h, A_A_re, A_A_im, A_B_re, A_B_im, A_C_re, A_C_im, A_log_dt, A_Dskip)
    h = _layernorm(x, axis=-1) * (1 + cb) + sb
    x = x + gb * _B_ref(h, B_w1, B_w2)
    return x
```

```asm
; @launch kernel=pc_kernel grid=(1014,1,1) block=(256,1,1) lds=40960
; @launch kernel=g12_kernel grid=(256,1,1) block=(512,1,1) lds=163840
.amdgcn_target "amdgcn-amd-amdhsa--gfx950"
.text
.globl pc_kernel
.p2align 8
.type pc_kernel,@function
pc_kernel:
    s_load_dwordx16 s[4:19], s[0:1], 8
    s_load_dwordx4 s[60:63], s[0:1], 120
    s_memrealtime s[54:55]
    s_cmp_ge_u32 s2, 256
    s_cbranch_scc1 pc_k
    s_setprio 3
    s_load_dwordx2 s[30:31], s[0:1], 0
    s_load_dwordx4 s[32:35], s[0:1], 120
    s_load_dwordx4 s[56:59], s[0:1], 96
    v_and_b32 v1, 63, v0
    v_lshrrev_b32 v2, 6, v0
    v_lshrrev_b32 v3, 4, v1
    v_readfirstlane_b32 s26, v2
    v_and_b32 v4, 15, v1
    s_cmp_ge_u32 s26, 2
    s_cbranch_scc1 l_mod
    v_lshrrev_b32 v5, 3, v1
    v_and_b32 v6, 7, v1
    v_xor_b32 v6, v6, v5
    v_mul_u32_u24 v7, 1280, v5
    v_lshl_add_u32 v8, v6, 4, v7
    s_mul_i32 s25, s2, 10240
    s_mul_i32 s28, s26, 640
    s_add_u32 s28, s28, s25
    s_mul_i32 s27, s26, 5120
    s_waitcnt lgkmcnt(0)
    s_mov_b32 s8, s30
    s_mov_b32 s9, s31
    s_mov_b32 s10, 2621440
    s_mov_b32 s11, 0x00020000
    s_add_u32 m0, s27, 0
    s_nop 0
    buffer_load_dwordx4 v8, s[8:11], s28 offen offset:0 lds
    s_add_u32 m0, s27, 896
    s_nop 0
    buffer_load_dwordx4 v8, s[8:11], s28 offen offset:128 lds
    s_add_u32 m0, s27, 1792
    s_nop 0
    buffer_load_dwordx4 v8, s[8:11], s28 offen offset:256 lds
    s_add_u32 m0, s27, 2688
    s_nop 0
    buffer_load_dwordx4 v8, s[8:11], s28 offen offset:384 lds
    s_add_u32 m0, s27, 3584
    s_nop 0
    buffer_load_dwordx4 v8, s[8:11], s28 offen offset:512 lds
    v_mov_b32 v20, 40000
    v_mov_b32 v21, 1
    s_cmp_eq_u32 s26, 1
    s_cbranch_scc1 l_tr
    s_add_u32 s12, s34, 2850816
    s_addc_u32 s13, s35, 0
    s_mov_b32 s14, 8192
    s_mov_b32 s15, 0x00020000
    v_mov_b32 v22, 0
    v_mov_b32 v23, 0
    ds_write_b64 v20, v[22:23]
    v_lshrrev_b32 v5, 3, v4
    v_and_b32 v6, 7, v4
    v_xor_b32 v7, v3, v5
    v_xor_b32 v7, v7, v6
    v_lshlrev_b32 v7, 4, v7
    v_lshl_add_u32 v7, v6, 7, v7
    v_mul_u32_u24 v5, 5120, v5
    v_add_u32 v10, v5, v7
    v_xor_b32 v11, 64, v10
    v_mov_b32 v32, 0x3f803f80
    v_mov_b32 v33, 0x3f803f80
    v_mov_b32 v34, 0x3f803f80
    v_mov_b32 v35, 0x3f803f80
    v_lshlrev_b32 v16, 2, v4
    s_lshl_b32 s25, s2, 5
    s_mov_b32 s40, 572662306
    s_mov_b32 s41, 572662306
    s_mov_b32 s42, 1145324612
    s_mov_b32 s43, 1145324612
    s_mov_b32 s44, 2290649224
    s_mov_b32 s45, 2290649224
    s_mov_b32 s46, 0x00f0000f
    s_mov_b32 s47, 0xf0000f00
    s_mov_b32 s23, 0xffff0000
    s_mov_b32 exec_lo, s46
    s_mov_b32 exec_hi, 0
    buffer_store_dword v22, v16, s[12:15], s25 offen sc1
    s_mov_b64 exec, -1
    s_waitcnt vmcnt(1) lgkmcnt(0)
    s_barrier
    ds_read_b128 v[48:51], v10 offset:0
    ds_read_b128 v[52:55], v11 offset:0
    ds_read_b128 v[56:59], v10 offset:1024
    ds_read_b128 v[60:63], v11 offset:1024
    ds_read_b128 v[64:67], v10 offset:2048
    ds_read_b128 v[68:71], v11 offset:2048
    ds_read_b128 v[72:75], v10 offset:3072
    ds_read_b128 v[76:79], v11 offset:3072
    ds_read_b128 v[80:83], v10 offset:4096
    ds_read_b128 v[84:87], v11 offset:4096
    s_waitcnt lgkmcnt(9)
    v_mfma_f32_16x16x32_bf16 v[44:47], v[48:51], v[48:51], 0
    v_mfma_f32_16x16x32_bf16 v[40:43], v[32:35], v[48:51], 0
    s_waitcnt lgkmcnt(8)
    v_mfma_f32_16x16x32_bf16 v[44:47], v[52:55], v[52:55], v[44:47]
    v_mfma_f32_16x16x32_bf16 v[40:43], v[32:35], v[52:55], v[40:43]
    s_waitcnt lgkmcnt(7)
    v_mfma_f32_16x16x32_bf16 v[44:47], v[56:59], v[56:59], v[44:47]
    v_mfma_f32_16x16x32_bf16 v[40:43], v[32:35], v[56:59], v[40:43]
    s_waitcnt lgkmcnt(6)
    v_mfma_f32_16x16x32_bf16 v[44:47], v[60:63], v[60:63], v[44:47]
    v_mfma_f32_16x16x32_bf16 v[40:43], v[32:35], v[60:63], v[40:43]
    s_waitcnt lgkmcnt(5)
    v_mfma_f32_16x16x32_bf16 v[44:47], v[64:67], v[64:67], v[44:47]
    v_mfma_f32_16x16x32_bf16 v[40:43], v[32:35], v[64:67], v[40:43]
    s_waitcnt lgkmcnt(4)
    v_mfma_f32_16x16x32_bf16 v[44:47], v[68:71], v[68:71], v[44:47]
    v_mfma_f32_16x16x32_bf16 v[40:43], v[32:35], v[68:71], v[40:43]
    s_waitcnt lgkmcnt(3)
    v_mfma_f32_16x16x32_bf16 v[44:47], v[72:75], v[72:75], v[44:47]
    v_mfma_f32_16x16x32_bf16 v[40:43], v[32:35], v[72:75], v[40:43]
    s_waitcnt lgkmcnt(2)
    v_mfma_f32_16x16x32_bf16 v[44:47], v[76:79], v[76:79], v[44:47]
    v_mfma_f32_16x16x32_bf16 v[40:43], v[32:35], v[76:79], v[40:43]
    s_waitcnt lgkmcnt(1)
    v_mfma_f32_16x16x32_bf16 v[44:47], v[80:83], v[80:83], v[44:47]
    v_mfma_f32_16x16x32_bf16 v[40:43], v[32:35], v[80:83], v[40:43]
    s_waitcnt lgkmcnt(0)
    v_mfma_f32_16x16x32_bf16 v[44:47], v[84:87], v[84:87], v[44:47]
    v_mfma_f32_16x16x32_bf16 v[40:43], v[32:35], v[84:87], v[40:43]
    s_nop 6
    v_cndmask_b32 v44, v44, v45, s[40:41]
    v_cndmask_b32 v44, v44, v46, s[42:43]
    v_cndmask_b32 v44, v44, v47, s[44:45]
    v_cndmask_b32 v41, 0, v44, s[46:47]
    v_add_f32_dpp v40, v40, v40 row_ror:8 row_mask:0xf bank_mask:0xf
    s_nop 0
    v_add_f32_dpp v41, v41, v41 row_ror:8 row_mask:0xf bank_mask:0xf
    v_mov_b32 v42, v41
    s_nop 1
    v_permlane32_swap_b32 v41, v42
    s_nop 1
    v_add_f32 v41, v41, v42
    s_mov_b32 s24, 986500301
    v_mul_f32 v40, s24, v40
    v_mul_f32 v41, s24, v41
    v_fma_f32 v41, -v40, v40, v41
    v_max_f32 v41, 0, v41
    v_cvt_pk_bf16_f32 v42, v40, v41
    v_lshlrev_b32 v40, 16, v42
    v_and_b32 v41, s23, v42
    v_add_f32 v41, 925353388, v41
    v_cvt_pk_bf16_f32 v41, v41, v41
    v_lshlrev_b32 v41, 16, v41
    v_sqrt_f32 v41, v41
    s_nop 0
    v_cvt_pk_bf16_f32 v41, v41, v41
    v_lshlrev_b32 v41, 16, v41
    v_rcp_f32 v42, v41
    v_lshrrev_b32 v40, 16, v40
    v_or_b32 v40, v40, v41
    s_mov_b32 exec_lo, s46
    s_mov_b32 exec_hi, 0
    buffer_store_dword v40, v16, s[12:15], s25 offen sc1
    s_mov_b64 exec, -1
    s_branch l_fin
l_tr:
    s_add_u32 s52, s34, 32768
    s_addc_u32 s53, s35, 0
    s_mov_b32 s54, 32768
    s_mov_b32 s55, 0x00020000
    v_lshlrev_b32 v12, 11, v1
    v_mov_b32 v14, 0
    v_mov_b32 v15, 0
    s_lshl_b32 s22, s2, 3
    s_mov_b64 exec, 65535
    buffer_store_dwordx2 v[14:15], v12, s[52:55], s22 offen sc1
    s_mov_b64 exec, -1
    s_add_u32 s12, s34, 65536
    s_addc_u32 s13, s35, 0
    s_mov_b32 s14, 2621440
    s_mov_b32 s15, 0x00020000
    v_bfe_u32 v5, v1, 2, 2
    v_bfe_u32 v6, v1, 1, 1
    v_lshl_add_u32 v6, v3, 1, v6
    v_xor_b32 v6, v6, v5
    v_lshlrev_b32 v6, 4, v6
    v_lshl_add_u32 v6, v5, 7, v6
    v_and_b32 v7, 1, v1
    v_lshl_add_u32 v10, v7, 3, v6
    v_xor_b32 v11, 64, v10
    v_lshlrev_b32 v16, 4, v1
    s_add_u32 s28, s25, 4096
    s_add_u32 s29, s25, 8192
    s_waitcnt vmcnt(1)
    s_barrier
    ds_read_b64_tr_b16 v[48:49], v10 offset:0
    ds_read_b64_tr_b16 v[50:51], v11 offset:512
    ds_read_b64_tr_b16 v[52:53], v10 offset:1024
    ds_read_b64_tr_b16 v[54:55], v11 offset:1536
    ds_read_b64_tr_b16 v[56:57], v10 offset:2048
    ds_read_b64_tr_b16 v[58:59], v11 offset:2560
    ds_read_b64_tr_b16 v[60:61], v10 offset:3072
    ds_read_b64_tr_b16 v[62:63], v11 offset:3584
    ds_read_b64_tr_b16 v[64:65], v10 offset:4096
    ds_read_b64_tr_b16 v[66:67], v11 offset:4608
    ds_read_b64_tr_b16 v[68:69], v10 offset:5120
    ds_read_b64_tr_b16 v[70:71], v11 offset:5632
    ds_read_b64_tr_b16 v[72:73], v10 offset:6144
    ds_read_b64_tr_b16 v[74:75], v11 offset:6656
    s_waitcnt lgkmcnt(12)
    buffer_store_dwordx4 v[48:51], v16, s[12:15], s25 offen offset:0 sc1
    ds_read_b64_tr_b16 v[76:77], v10 offset:7168
    ds_read_b64_tr_b16 v[78:79], v11 offset:7680
    s_waitcnt lgkmcnt(12)
    buffer_store_dwordx4 v[52:55], v16, s[12:15], s25 offen offset:1024 sc1
    ds_read_b64_tr_b16 v[80:81], v10 offset:8192
    ds_read_b64_tr_b16 v[82:83], v11 offset:8704
    s_waitcnt lgkmcnt(12)
    buffer_store_dwordx4 v[56:59], v16, s[12:15], s25 offen offset:2048 sc1
    ds_read_b64_tr_b16 v[84:85], v10 offset:9216
    ds_read_b64_tr_b16 v[86:87], v11 offset:9728
    s_waitcnt lgkmcnt(12)
    buffer_store_dwordx4 v[60:63], v16, s[12:15], s25 offen offset:3072 sc1
    s_waitcnt lgkmcnt(10)
    buffer_store_dwordx4 v[64:67], v16, s[12:15], s28 offen offset:0 sc1
    s_waitcnt lgkmcnt(8)
    buffer_store_dwordx4 v[68:71], v16, s[12:15], s28 offen offset:1024 sc1
    s_waitcnt lgkmcnt(6)
    buffer_store_dwordx4 v[72:75], v16, s[12:15], s28 offen offset:2048 sc1
    s_waitcnt lgkmcnt(4)
    buffer_store_dwordx4 v[76:79], v16, s[12:15], s28 offen offset:3072 sc1
    s_waitcnt lgkmcnt(2)
    buffer_store_dwordx4 v[80:83], v16, s[12:15], s29 offen offset:0 sc1
    s_waitcnt lgkmcnt(0)
    buffer_store_dwordx4 v[84:87], v16, s[12:15], s29 offen offset:1024 sc1
l_fin:
    s_add_u32 s52, s34, 32768
    s_addc_u32 s53, s35, 0
    s_mov_b32 s54, 32768
    s_mov_b32 s55, 0x00020000
    v_lshlrev_b32 v8, 11, v1
    s_lshl_b32 s22, s2, 3
    s_mov_b64 exec, 1
    s_waitcnt vmcnt(0)
    ds_add_rtn_u32 v22, v20, v21
    s_memrealtime s[20:21]
    s_waitcnt lgkmcnt(0)
    v_readfirstlane_b32 s23, v22
    s_mov_b64 exec, 65535
    v_mov_b32 v10, s20
    v_mov_b32 v11, s21
    s_bitcmp1_b32 s23, 0
    s_cbranch_scc0 l_nofl
    buffer_store_dwordx2 v[10:11], v8, s[52:55], s22 offen sc1
l_nofl:
    s_add_u32 s23, s23, 1
    s_branch l_cnt
l_mod:
    v_lshrrev_b32 v5, 3, v1
    v_and_b32 v6, 6, v5
    v_and_b32 v7, 7, v1
    v_xor_b32 v8, v7, v6
    v_mul_u32_u24 v9, 7680, v5
    v_lshl_add_u32 v9, v8, 4, v9
    v_lshlrev_b32 v10, 5, v4
    v_lshl_add_u32 v10, v3, 3, v10
    s_and_b32 s36, s2, 3
    s_lshr_b32 s37, s2, 2
    s_sub_u32 s38, s26, 2
    s_mul_i32 s20, s36, 1228800
    s_lshl_b32 s21, s37, 7
    s_add_u32 s20, s20, s21
    s_mul_i32 s21, s38, 61440
    s_add_u32 s20, s20, s21
    s_lshl_b32 s21, s38, 10
    s_mul_i32 s22, s36, 320
    v_mov_b32 v22, 40000
    v_mov_b32 v23, 16
    s_cmp_ge_u32 s2, 240
    s_cbranch_scc0 l_m1
    s_waitcnt lgkmcnt(0)
    s_barrier
    s_branch l_mfin
l_m1:
    s_memrealtime s[44:45]
    s_and_b32 s23, s2, 15
    s_or_b32 s23, s23, s38
    s_waitcnt lgkmcnt(0)
    s_mov_b32 s47, s44
    s_cmp_lg_u32 s23, 0
    s_cbranch_scc1 l_noreg
    s_mov_b32 s48, s32
    s_mov_b32 s49, s33
    s_mov_b32 s50, 256
    s_mov_b32 s51, 0x00020000
    s_not_b64 s[44:45], s[44:45]
    v_mov_b32 v24, s44
    v_mov_b32 v25, s45
    s_mov_b64 exec, 1
    buffer_atomic_umax_x2 v[24:25], off, s[48:51], 0 offset:32
    s_mov_b64 exec, -1
l_noreg:
    s_mov_b32 s8, s56
    s_mov_b32 s9, s57
    s_mov_b32 s10, 1280
    s_mov_b32 s11, 0x00020000
    s_mov_b32 s12, s58
    s_mov_b32 s13, s59
    s_mov_b32 s14, 4915200
    s_mov_b32 s15, 0x00020000
    s_add_u32 s52, s34, 5636096
    s_addc_u32 s53, s35, 0
    s_mov_b32 s54, 245760
    s_mov_b32 s55, 0x00020000
    buffer_load_dwordx2 v[12:13], v10, s[8:11], s22 offen
    s_cmp_ge_u32 s2, 128
    s_cbranch_scc1 l_noscw
    s_getpc_b64 s[60:61]
l_scw_pc:
    s_lshr_b32 s62, s2, 3
    s_lshl_b32 s62, s62, 1
    s_add_u32 s62, s62, s38
    s_mul_i32 s62, s62, 64
    s_add_u32 s62, s62, pc_h-l_scw_pc
    s_load_dword s64, s[60:61], s62 offset:0
    s_load_dword s65, s[60:61], s62 offset:2048
    s_load_dword s66, s[60:61], s62 offset:4096
    s_load_dword s67, s[60:61], s62 offset:6144
    s_load_dword s68, s[60:61], s62 offset:8192
    s_load_dword s69, s[60:61], s62 offset:10240
    s_load_dword s70, s[60:61], s62 offset:12288
l_noscw:
    s_cmp_lt_u32 s2, 120
    s_cbranch_scc1 l_mb1
    s_barrier
l_mb1:
    s_cmp_lt_u32 s2, 120
    s_cselect_b32 s72, 100, 0
    s_sub_u32 s47, s47, s72
    s_mov_b32 s74, 0
l_mgate:
    s_memrealtime s[72:73]
    s_add_u32 s74, s74, 1
    s_waitcnt lgkmcnt(0)
    s_sub_u32 s72, s72, s47
    s_cmp_ge_u32 s72, 180
    s_cbranch_scc1 l_mgate_e
    s_sleep 2
    s_cmp_lt_u32 s74, 256
    s_cbranch_scc1 l_mgate
l_mgate_e:
    s_add_u32 m0, s21, 10240
    s_add_u32 s23, s20, 0
    buffer_load_dwordx4 v9, s[12:15], s23 offen lds
    s_add_u32 m0, s21, 12288
    s_add_u32 s23, s20, 122880
    buffer_load_dwordx4 v9, s[12:15], s23 offen lds
    s_add_u32 m0, s21, 14336
    s_add_u32 s23, s20, 245760
    buffer_load_dwordx4 v9, s[12:15], s23 offen lds
    s_add_u32 m0, s21, 16384
    s_add_u32 s23, s20, 368640
    buffer_load_dwordx4 v9, s[12:15], s23 offen lds
    s_add_u32 m0, s21, 18432
    s_add_u32 s23, s20, 491520
    buffer_load_dwordx4 v9, s[12:15], s23 offen lds
    s_add_u32 m0, s21, 20480
    s_add_u32 s23, s20, 614400
    buffer_load_dwordx4 v9, s[12:15], s23 offen lds
    s_add_u32 m0, s21, 22528
    s_add_u32 s23, s20, 737280
    buffer_load_dwordx4 v9, s[12:15], s23 offen lds
    s_add_u32 m0, s21, 24576
    s_add_u32 s23, s20, 860160
    buffer_load_dwordx4 v9, s[12:15], s23 offen lds
    s_add_u32 m0, s21, 26624
    s_add_u32 s23, s20, 983040
    buffer_load_dwordx4 v9, s[12:15], s23 offen lds
    s_add_u32 m0, s21, 28672
    s_add_u32 s23, s20, 1105920
    buffer_load_dwordx4 v9, s[12:15], s23 offen lds
    s_cmp_ge_u32 s2, 120
    s_cbranch_scc1 l_mb2
    s_barrier
l_mb2:
    v_lshrrev_b32 v5, 2, v1
    v_and_b32 v6, 6, v5
    v_bfe_u32 v8, v1, 1, 1
    s_lshl_b32 s21, s38, 2
    v_add_u32 v8, s21, v8
    v_xor_b32 v8, v8, v6
    v_lshlrev_b32 v8, 4, v8
    v_lshl_add_u32 v8, v5, 7, v8
    v_and_b32 v7, 1, v1
    v_lshl_add_u32 v8, v7, 3, v8
    v_xor_b32 v9, 32, v8
    s_mov_b32 s28, 0xaaaaaaaa
    s_mov_b32 s29, 0xaaaaaaaa
    s_mov_b32 s30, 0xffff0000
    s_mov_b32 s31, 0
    s_mov_b32 s40, 0
    s_mov_b32 s41, 0xffff
    s_mov_b32 s42, 0
    s_mov_b32 s43, 0xffff0000
    s_mov_b32 s21, 1069066811
    s_mul_i32 s20, s36, 61440
    s_lshl_b32 s37, s37, 10
    s_add_u32 s20, s20, s37
    s_lshl_b32 s38, s38, 9
    s_add_u32 s20, s20, s38
    v_lshlrev_b32 v2, 4, v1
    s_waitcnt vmcnt(10)
    v_lshlrev_b32 v14, 16, v12
    v_and_b32 v15, 0xffff0000, v12
    v_lshlrev_b32 v16, 16, v13
    v_and_b32 v17, 0xffff0000, v13
    v_mul_f32 v18, s21, v14
    v_mul_f32 v19, s21, v15
    v_mul_f32 v20, s21, v16
    v_mul_f32 v21, s21, v17
    v_exp_f32 v18, -v18
    v_exp_f32 v19, -v19
    v_exp_f32 v20, -v20
    v_exp_f32 v21, -v21
    v_add_f32 v18, 1.0, v18
    v_add_f32 v19, 1.0, v19
    v_add_f32 v20, 1.0, v20
    v_add_f32 v21, 1.0, v21
    v_rcp_f32 v18, v18
    v_rcp_f32 v19, v19
    v_rcp_f32 v20, v20
    v_rcp_f32 v21, v21
    v_mul_f32 v18, v14, v18
    v_mul_f32 v19, v15, v19
    v_mul_f32 v20, v16, v20
    v_mul_f32 v21, v17, v21
    v_cvt_pk_bf16_f32 v12, v18, v19
    v_cvt_pk_bf16_f32 v13, v20, v21
    v_cndmask_b32 v16, v12, 0, s[28:29]
    v_cndmask_b32 v17, v13, 0, s[28:29]
    v_cndmask_b32 v18, 0, v12, s[28:29]
    v_cndmask_b32 v19, 0, v13, s[28:29]
    v_mov_b32 v24, 1
    s_mov_b32 s23, 0
    s_waitcnt vmcnt(0)
    s_mov_b64 exec, 1
    ds_add_u32 v22, v24 offset:4
    s_mov_b64 exec, -1
l_msync:
    ds_read_b32 v24, v22 offset:4
    s_add_u32 s23, s23, 1
    s_waitcnt lgkmcnt(0)
    v_readfirstlane_b32 s22, v24
    s_cmp_eq_u32 s22, 2
    s_cbranch_scc1 l_mgo
    s_cmp_lt_u32 s23, 32768
    s_cbranch_scc1 l_msync
l_mgo:
    ds_read_b64_tr_b16 v[40:41], v8 offset:10240
    ds_read_b64_tr_b16 v[42:43], v8 offset:12288
    ds_read_b64_tr_b16 v[44:45], v9 offset:10240
    ds_read_b64_tr_b16 v[46:47], v9 offset:12288
    ds_read_b64_tr_b16 v[48:49], v8 offset:14336
    ds_read_b64_tr_b16 v[50:51], v8 offset:16384
    ds_read_b64_tr_b16 v[52:53], v9 offset:14336
    ds_read_b64_tr_b16 v[54:55], v9 offset:16384
    ds_read_b64_tr_b16 v[56:57], v8 offset:18432
    ds_read_b64_tr_b16 v[58:59], v8 offset:20480
    ds_read_b64_tr_b16 v[60:61], v9 offset:18432
    ds_read_b64_tr_b16 v[62:63], v9 offset:20480
    s_waitcnt lgkmcnt(10)
    v_mfma_f32_16x16x32_bf16 v[80:83], v[16:19], v[40:43], 0
    s_waitcnt lgkmcnt(8)
    v_mfma_f32_16x16x32_bf16 v[84:87], v[16:19], v[44:47], 0
    ds_read_b64_tr_b16 v[64:65], v8 offset:22528
    ds_read_b64_tr_b16 v[66:67], v8 offset:24576
    ds_read_b64_tr_b16 v[68:69], v9 offset:22528
    ds_read_b64_tr_b16 v[70:71], v9 offset:24576
    s_waitcnt lgkmcnt(10)
    v_mfma_f32_16x16x32_bf16 v[88:91], v[16:19], v[48:51], 0
    s_waitcnt lgkmcnt(8)
    v_mfma_f32_16x16x32_bf16 v[92:95], v[16:19], v[52:55], 0
    ds_read_b64_tr_b16 v[72:73], v8 offset:26624
    ds_read_b64_tr_b16 v[74:75], v8 offset:28672
    ds_read_b64_tr_b16 v[76:77], v9 offset:26624
    ds_read_b64_tr_b16 v[78:79], v9 offset:28672
    s_waitcnt lgkmcnt(10)
    v_mfma_f32_16x16x32_bf16 v[96:99], v[16:19], v[56:59], 0
    s_waitcnt lgkmcnt(8)
    v_mfma_f32_16x16x32_bf16 v[100:103], v[16:19], v[60:63], 0
    s_waitcnt lgkmcnt(6)
    v_mfma_f32_16x16x32_bf16 v[104:107], v[16:19], v[64:67], 0
    s_waitcnt lgkmcnt(4)
    v_mfma_f32_16x16x32_bf16 v[108:111], v[16:19], v[68:71], 0
    s_waitcnt lgkmcnt(2)
    v_mfma_f32_16x16x32_bf16 v[112:115], v[16:19], v[72:75], 0
    s_waitcnt lgkmcnt(0)
    v_mfma_f32_16x16x32_bf16 v[116:119], v[16:19], v[76:79], 0
    s_memrealtime s[36:37]
    s_nop 3
    v_add_f32 v80, v80, v81
    v_add_f32 v90, v90, v91
    v_add_f32 v80, v80, v90
    v_add_f32 v96, v96, v97
    v_add_f32 v106, v106, v107
    v_add_f32 v96, v96, v106
    v_add_f32 v84, v84, v85
    v_add_f32 v94, v94, v95
    v_add_f32 v84, v84, v94
    v_add_f32 v100, v100, v101
    v_add_f32 v110, v110, v111
    v_add_f32 v100, v100, v110
    v_add_f32 v112, v112, v113
    v_cndmask_b32 v80, v80, v96, s[30:31]
    v_cndmask_b32 v80, v80, v112, s[40:41]
    v_cndmask_b32 v80, v80, 0, s[42:43]
    v_add_f32 v116, v116, v117
    v_cndmask_b32 v84, v84, v100, s[30:31]
    v_cndmask_b32 v84, v84, v116, s[40:41]
    v_cndmask_b32 v84, v84, 0, s[42:43]
    v_mov_b32 v19, 0
    s_nop 0
    v_permlane16_swap_b32 v80, v84
    s_nop 1
    v_add_f32 v18, v80, v84
    v_mov_b32 v20, v18
    s_waitcnt lgkmcnt(0)
    v_mov_b32 v16, s36
    v_permlane32_swap_b32 v18, v20
    v_mov_b32 v17, s37
    s_mov_b32 exec_hi, 0
    v_add_f32 v18, v18, v20
    buffer_store_dwordx4 v[16:19], v2, s[52:55], s20 offen sc1
l_mfin:
    s_mov_b64 exec, 1
    s_waitcnt vmcnt(0)
    ds_add_rtn_u32 v22, v22, v23
    s_waitcnt lgkmcnt(0)
    v_readfirstlane_b32 s23, v22
    s_add_u32 s23, s23, 16
l_cnt:
    s_cmp_lg_u32 s23, 0x22
    s_cbranch_scc1 l_end
    s_mov_b32 s48, s32
    s_mov_b32 s49, s33
    s_mov_b32 s50, 256
    s_mov_b32 s51, 0x00020000
    s_and_b32 s22, s2, 3
    s_lshl_b32 s22, s22, 6
    s_mov_b64 exec, 1
    v_mov_b32 v12, 1
    buffer_atomic_add v12, off, s[48:51], s22
l_end:
    s_mov_b64 exec, -1
    s_cmp_ge_u32 s2, 64
    s_cbranch_scc1 l_nocw
    s_getpc_b64 s[84:85]
cw_pc0:
    s_add_u32 s84, s84, g12_kernel-cw_pc0
    s_addc_u32 s85, s85, 0
    s_mov_b32 s86, g12_end-g12_kernel
    s_mov_b32 s87, 0x00020000
    v_lshlrev_b32 v123, 7, v0
    buffer_load_dword v124, v123, s[84:87], 0 offen
    s_waitcnt vmcnt(0)
l_nocw:
    s_endpgm
pc_h:
    s_waitcnt lgkmcnt(0)
    s_mov_b32 s62, s54
    s_sub_u32 s2, s2, 640
    s_cmp_ge_u32 s2, 108
    s_cbranch_scc1 pc_g
    s_setprio 3
    s_load_dwordx4 s[4:7], s[0:1], 120
    s_load_dwordx4 s[24:27], s[0:1], 80
    s_memrealtime s[56:57]
    s_lshr_b32 s20, s2, 1
    s_and_b32 s21, s2, 1
    s_mul_i32 s3, s20, 40960
    s_mul_i32 s22, s21, 640
    s_add_u32 s3, s3, s22
    v_lshlrev_b32 v1, 4, v0
    s_mul_i32 s22, s21, 216
    s_add_u32 s22, s22, s20
    s_mul_i32 s22, s22, 5120
    s_mul_i32 s28, s2, 2428
    s_lshr_b32 s28, s28, 16
    s_mul_i32 s29, s28, 27
    s_sub_u32 s29, s2, s29
    s_lshl_b32 s29, s29, 7
    s_mul_i32 s30, s28, 552960
    s_add_u32 s30, s30, s29
    v_lshrrev_b32 v13, 3, v0
    v_and_b32 v14, 7, v0
    v_mul_u32_u24 v15, 3456, v13
    v_lshl_add_u32 v15, v14, 4, v15
    v_lshlrev_b32 v13, 2, v13
    v_add_u32 v2, 0, v0
    v_mul_u32_u24 v3, 26215, v2
    v_lshrrev_b32 v3, 20, v3
    v_mul_u32_u24 v4, 640, v3
    v_add_u32 v8, v4, v1
    v_lshl_add_u32 v86, v3, 5, v1
    v_add_u32 v2, 256, v0
    v_mul_u32_u24 v3, 26215, v2
    v_lshrrev_b32 v3, 20, v3
    v_mul_u32_u24 v4, 640, v3
    v_add_u32 v9, v4, v1
    v_lshl_add_u32 v87, v3, 5, v1
    v_add_u32 v2, 512, v0
    v_mul_u32_u24 v3, 26215, v2
    v_lshrrev_b32 v3, 20, v3
    v_mul_u32_u24 v4, 640, v3
    v_add_u32 v10, v4, v1
    v_lshl_add_u32 v88, v3, 5, v1
    v_add_u32 v2, 768, v0
    v_mul_u32_u24 v3, 26215, v2
    v_lshrrev_b32 v3, 20, v3
    v_mul_u32_u24 v4, 640, v3
    v_add_u32 v11, v4, v1
    v_lshl_add_u32 v89, v3, 5, v1
    v_add_u32 v2, 1024, v0
    v_mul_u32_u24 v3, 26215, v2
    v_lshrrev_b32 v3, 20, v3
    v_mul_u32_u24 v4, 640, v3
    v_add_u32 v12, v4, v1
    v_lshl_add_u32 v90, v3, 5, v1
    s_waitcnt lgkmcnt(0)
    s_mov_b32 s8, s26
    s_mov_b32 s9, s27
    s_mov_b32 s10, 2211840
    s_mov_b32 s11, 0x00020000
    s_add_u32 s12, s6, 21348352
    s_addc_u32 s13, s7, 0
    s_mov_b32 s14, 2211840
    s_mov_b32 s15, 0x00020000
    s_mov_b32 s16, s24
    s_mov_b32 s17, s25
    s_mov_b32 s18, 2211840
    s_mov_b32 s19, 0x00020000
    s_add_u32 s32, s6, 23560192
    s_addc_u32 s33, s7, 0
    s_mov_b32 s34, 2322432
    s_mov_b32 s35, 0x00020000
    s_mov_b32 s48, s4
    s_mov_b32 s49, s5
    s_mov_b32 s50, 256
    s_mov_b32 s51, 0x00020000
    s_add_u32 s52, s6, 5636096
    s_addc_u32 s53, s7, 0
    s_mov_b32 s54, 245760
    s_mov_b32 s55, 0x00020000
    v_and_b32 v2, 3, v0
    v_mul_u32_u24 v2, 61440, v2
    v_lshrrev_b32 v3, 2, v0
    v_lshl_add_u32 v112, v3, 4, v2
    v_add_u32 v113, 7680, v112
    v_mov_b32 v116, s56
    v_mov_b32 v117, s57
    v_subrev_co_u32 v116, vcc, 200, v116
    v_subbrev_co_u32 v117, vcc, 0, v117, vcc
    v_cmp_gt_u32 vcc, 32, v3
    s_nop 1
    v_cndmask_b32 v114, v113, v112, vcc
    v_add_u32 v115, 4096, v113
    v_lshlrev_b32 v118, 2, v3
    s_mul_i32 s31, s28, 2560
    s_add_u32 s31, s31, 30720
    s_mov_b32 s60, 4194304
    s_mov_b32 s61, 0
    s_mov_b32 s46, 0
hq_gate:
    s_memrealtime s[44:45]
    s_add_u32 s46, s46, 1
    s_waitcnt lgkmcnt(0)
    s_sub_u32 s44, s44, s62
    s_cmp_ge_u32 s44, 450
    s_cbranch_scc1 hq_gate_e
    s_sleep 8
    s_cmp_lt_u32 s46, 256
    s_cbranch_scc1 hq_gate
hq_gate_e:
    s_add_u32 s23, s3, 0
    buffer_load_dwordx4 v[16:19], v8, s[8:11], s23 offen
    s_add_u32 s23, s3, 4096
    buffer_load_dwordx4 v[20:23], v9, s[8:11], s23 offen
    s_add_u32 s23, s3, 8192
    buffer_load_dwordx4 v[24:27], v10, s[8:11], s23 offen
    s_add_u32 s23, s3, 12288
    buffer_load_dwordx4 v[28:31], v11, s[8:11], s23 offen
    s_add_u32 s23, s3, 16384
    buffer_load_dwordx4 v[32:35], v12, s[8:11], s23 offen
    s_add_u32 s23, s30, 0
    buffer_load_dwordx4 v[36:39], v15, s[16:19], s23 offen
    s_add_u32 s23, s30, 110592
    buffer_load_dwordx4 v[40:43], v15, s[16:19], s23 offen
    s_add_u32 s23, s30, 221184
    buffer_load_dwordx4 v[44:47], v15, s[16:19], s23 offen
    s_add_u32 s23, s30, 331776
    buffer_load_dwordx4 v[48:51], v15, s[16:19], s23 offen
    s_add_u32 s23, s30, 442368
    buffer_load_dwordx4 v[52:55], v15, s[16:19], s23 offen
    buffer_load_dwordx4 v[92:95], v112, s[52:55], s31 offen offset:0
    buffer_load_dwordx4 v[96:99], v112, s[52:55], s31 offen offset:1024
    buffer_load_dwordx4 v[100:103], v114, s[52:55], s31 offen offset:2048
    buffer_load_dwordx4 v[104:107], v113, s[52:55], s31 offen offset:3072
    buffer_load_dwordx4 v[108:111], v115, s[52:55], s31 offen offset:0
    s_mov_b32 s40, 0xffff0000
    v_mov_b32 v66, 0
    v_mov_b32 v67, 0
    v_mov_b32 v68, 0
    v_mov_b32 v69, 0
    v_mov_b32 v70, 0
    v_mov_b32 v71, 0
    v_mov_b32 v72, 0
    v_mov_b32 v73, 0
    v_mov_b32 v74, 0
    v_mov_b32 v75, 0
    v_mov_b32 v76, 0
    v_mov_b32 v77, 0
    v_mov_b32 v78, 0
    v_mov_b32 v79, 0
    v_mov_b32 v80, 0
    v_mov_b32 v81, 0
    v_mul_u32_u24 v15, 40, v13
    v_lshl_add_u32 v15, v14, 4, v15
    v_lshrrev_b32 v84, 6, v0
    s_nop 0
    v_readfirstlane_b32 s59, v84
    v_and_b32 v1, 63, v0
    v_lshrrev_b32 v9, 2, v1
    v_mul_u32_u24 v9, 672, v9
    v_and_b32 v10, 3, v1
    v_lshl_add_u32 v9, v10, 3, v9
    v_mul_u32_u24 v11, 160, v84
    v_add_u32 v9, v9, v11
    v_lshlrev_b32 v8, 4, v1
    s_mul_i32 s23, s59, 276480
    s_add_u32 s22, s22, s23
    s_waitcnt vmcnt(14)
    ds_write_b128 v86, v[16:19] offset:0
    s_waitcnt vmcnt(13)
    ds_write_b128 v87, v[20:23] offset:4096
    s_waitcnt vmcnt(12)
    ds_write_b128 v88, v[24:27] offset:8192
    s_waitcnt vmcnt(11)
    ds_write_b128 v89, v[28:31] offset:12288
    s_waitcnt vmcnt(10)
    ds_write_b128 v90, v[32:35] offset:16384
    s_waitcnt lgkmcnt(0)
    s_barrier
    ds_read_b64_tr_b16 v[16:17], v9 offset:0
    ds_read_b64_tr_b16 v[18:19], v9 offset:10752
    ds_read_b64_tr_b16 v[20:21], v9 offset:32
    ds_read_b64_tr_b16 v[22:23], v9 offset:10784
    ds_read_b64_tr_b16 v[24:25], v9 offset:64
    ds_read_b64_tr_b16 v[26:27], v9 offset:10816
    ds_read_b64_tr_b16 v[28:29], v9 offset:96
    ds_read_b64_tr_b16 v[30:31], v9 offset:10848
    ds_read_b64_tr_b16 v[32:33], v9 offset:128
    ds_read_b64_tr_b16 v[34:35], v9 offset:10880
    s_add_u32 s23, s22, 4096
    s_waitcnt lgkmcnt(8)
    buffer_store_dwordx4 v[16:19], v8, s[12:15], s22 offen offset:0 sc0 sc1
    s_waitcnt lgkmcnt(6)
    buffer_store_dwordx4 v[20:23], v8, s[12:15], s22 offen offset:1024 sc0 sc1
    s_waitcnt lgkmcnt(4)
    buffer_store_dwordx4 v[24:27], v8, s[12:15], s22 offen offset:2048 sc0 sc1
    s_waitcnt lgkmcnt(2)
    buffer_store_dwordx4 v[28:31], v8, s[12:15], s22 offen offset:3072 sc0 sc1
    s_waitcnt lgkmcnt(0)
    buffer_store_dwordx4 v[32:35], v8, s[12:15], s23 offen offset:0 sc0 sc1
    s_mov_b32 s44, 0
    s_waitcnt vmcnt(5)
    v_sub_co_u32 v92, vcc, v92, v116
    v_subb_co_u32 v93, vcc, v93, v117, vcc
    v_cmp_gt_u64 s[46:47], s[60:61], v[92:93]
    v_sub_co_u32 v96, vcc, v96, v116
    v_subb_co_u32 v97, vcc, v97, v117, vcc
    v_cmp_gt_u64 vcc, s[60:61], v[96:97]
    s_and_b64 s[46:47], s[46:47], vcc
    v_sub_co_u32 v100, vcc, v100, v116
    v_subb_co_u32 v101, vcc, v101, v117, vcc
    v_cmp_gt_u64 vcc, s[60:61], v[100:101]
    s_and_b64 s[46:47], s[46:47], vcc
    v_sub_co_u32 v104, vcc, v104, v116
    v_subb_co_u32 v105, vcc, v105, v117, vcc
    v_cmp_gt_u64 vcc, s[60:61], v[104:105]
    s_and_b64 s[46:47], s[46:47], vcc
    v_sub_co_u32 v108, vcc, v108, v116
    v_subb_co_u32 v109, vcc, v109, v117, vcc
    v_cmp_gt_u64 vcc, s[60:61], v[108:109]
    s_and_b64 s[46:47], s[46:47], vcc
    s_cmp_eq_u64 s[46:47], -1
    s_cbranch_scc1 hq_ok
hq_loop:
    s_and_b32 s46, s44, 3
    s_cmp_eq_u32 s46, 3
    s_cbranch_scc1 hq_t0
    buffer_load_dwordx4 v[92:95], v112, s[52:55], s31 offen offset:0 sc1
    buffer_load_dwordx4 v[96:99], v112, s[52:55], s31 offen offset:1024 sc1
    buffer_load_dwordx4 v[100:103], v114, s[52:55], s31 offen offset:2048 sc1
    buffer_load_dwordx4 v[104:107], v113, s[52:55], s31 offen offset:3072 sc1
    buffer_load_dwordx4 v[108:111], v115, s[52:55], s31 offen offset:0 sc1
    s_branch hq_t
hq_t0:
    buffer_load_dwordx2 v[120:121], off, s[48:51], 0 offset:32 sc1
    buffer_load_dwordx4 v[92:95], v112, s[52:55], s31 offen offset:0 sc1
    buffer_load_dwordx4 v[96:99], v112, s[52:55], s31 offen offset:1024 sc1
    buffer_load_dwordx4 v[100:103], v114, s[52:55], s31 offen offset:2048 sc1
    buffer_load_dwordx4 v[104:107], v113, s[52:55], s31 offen offset:3072 sc1
    buffer_load_dwordx4 v[108:111], v115, s[52:55], s31 offen offset:0 sc1
    s_waitcnt vmcnt(5)
    v_not_b32 v120, v120
    v_not_b32 v121, v121
    v_cmp_lt_u64 vcc, v[120:121], v[116:117]
    s_nop 1
    v_cndmask_b32 v116, v116, v120, vcc
    v_cndmask_b32 v117, v117, v121, vcc
hq_t:
    s_waitcnt vmcnt(4)
    v_sub_co_u32 v92, vcc, v92, v116
    v_subb_co_u32 v93, vcc, v93, v117, vcc
    v_cmp_gt_u64 s[46:47], s[60:61], v[92:93]
    s_waitcnt vmcnt(3)
    v_sub_co_u32 v96, vcc, v96, v116
    v_subb_co_u32 v97, vcc, v97, v117, vcc
    v_cmp_gt_u64 vcc, s[60:61], v[96:97]
    s_and_b64 s[46:47], s[46:47], vcc
    s_waitcnt vmcnt(2)
    v_sub_co_u32 v100, vcc, v100, v116
    v_subb_co_u32 v101, vcc, v101, v117, vcc
    v_cmp_gt_u64 vcc, s[60:61], v[100:101]
    s_and_b64 s[46:47], s[46:47], vcc
    s_waitcnt vmcnt(1)
    v_sub_co_u32 v104, vcc, v104, v116
    v_subb_co_u32 v105, vcc, v105, v117, vcc
    v_cmp_gt_u64 vcc, s[60:61], v[104:105]
    s_and_b64 s[46:47], s[46:47], vcc
    s_waitcnt vmcnt(0)
    v_sub_co_u32 v108, vcc, v108, v116
    v_subb_co_u32 v109, vcc, v109, v117, vcc
    v_cmp_gt_u64 vcc, s[60:61], v[108:109]
    s_and_b64 s[46:47], s[46:47], vcc
    s_cmp_eq_u64 s[46:47], -1
    s_cbranch_scc1 hq_ok
    s_add_u32 s44, s44, 1
    s_cmp_eq_u32 s44, 1
    s_cbranch_scc1 hq_loop
    s_sleep 16
    s_and_b32 s46, s44, 15
    s_cbranch_scc1 hq_next
    s_mov_b64 exec, 15
    v_lshlrev_b32 v92, 6, v1
    buffer_load_dword v92, v92, s[48:51], 0 offen sc1
    s_waitcnt vmcnt(0)
    v_cmp_eq_u32 vcc, 64, v92
    s_mov_b64 exec, -1
    s_cmp_eq_u32 vcc_lo, 15
    s_cbranch_scc0 hq_next
    buffer_load_dwordx4 v[92:95], v112, s[52:55], s31 offen offset:0 sc1
    buffer_load_dwordx4 v[96:99], v112, s[52:55], s31 offen offset:1024 sc1
    buffer_load_dwordx4 v[100:103], v114, s[52:55], s31 offen offset:2048 sc1
    buffer_load_dwordx4 v[104:107], v113, s[52:55], s31 offen offset:3072 sc1
    buffer_load_dwordx4 v[108:111], v115, s[52:55], s31 offen offset:0 sc1
    s_waitcnt vmcnt(0)
    s_branch hq_ok
hq_next:
    s_cmp_lt_u32 s44, 32768
    s_cbranch_scc1 hq_loop
hq_ok:
    v_add_f32_dpp v94, v94, v94 quad_perm:[1,0,3,2] row_mask:0xf bank_mask:0xf
    v_add_f32_dpp v98, v98, v98 quad_perm:[1,0,3,2] row_mask:0xf bank_mask:0xf
    v_add_f32_dpp v102, v102, v102 quad_perm:[1,0,3,2] row_mask:0xf bank_mask:0xf
    v_add_f32_dpp v106, v106, v106 quad_perm:[1,0,3,2] row_mask:0xf bank_mask:0xf
    v_add_f32_dpp v110, v110, v110 quad_perm:[1,0,3,2] row_mask:0xf bank_mask:0xf
    v_add_f32_dpp v94, v94, v94 quad_perm:[2,3,0,1] row_mask:0xf bank_mask:0xf
    v_add_f32_dpp v98, v98, v98 quad_perm:[2,3,0,1] row_mask:0xf bank_mask:0xf
    v_add_f32_dpp v102, v102, v102 quad_perm:[2,3,0,1] row_mask:0xf bank_mask:0xf
    v_add_f32_dpp v106, v106, v106 quad_perm:[2,3,0,1] row_mask:0xf bank_mask:0xf
    v_add_f32_dpp v110, v110, v110 quad_perm:[2,3,0,1] row_mask:0xf bank_mask:0xf
    v_cvt_pk_bf16_f32 v94, v94, v94
    v_cvt_pk_bf16_f32 v98, v98, v98
    v_cvt_pk_bf16_f32 v102, v102, v102
    v_cvt_pk_bf16_f32 v106, v106, v106
    v_cvt_pk_bf16_f32 v110, v110, v110
    v_lshlrev_b32 v94, 16, v94
    v_lshlrev_b32 v98, 16, v98
    v_lshlrev_b32 v102, 16, v102
    v_lshlrev_b32 v106, 16, v106
    v_lshlrev_b32 v110, 16, v110
    ds_write_b32 v118, v94 offset:36864
    ds_write_b32 v118, v98 offset:37120
    ds_write_b32 v118, v102 offset:37376
    ds_write_b32 v118, v106 offset:37632
    ds_write_b32 v118, v110 offset:37888
    s_waitcnt lgkmcnt(0)
    s_barrier
    ds_read_b32 v56, v13 offset:36864
    ds_read_b32 v61, v13 offset:37504
    ds_read_b32 v57, v13 offset:36992
    ds_read_b32 v62, v13 offset:37632
    ds_read_b32 v58, v13 offset:37120
    ds_read_b32 v63, v13 offset:37760
    ds_read_b32 v59, v13 offset:37248
    ds_read_b32 v64, v13 offset:37888
    ds_read_b32 v60, v13 offset:37376
    ds_read_b32 v65, v13 offset:38016
    s_waitcnt lgkmcnt(0)
    v_add_f32 v61, 1.0, v61
    v_cvt_pk_bf16_f32 v61, v61, v61
    v_lshlrev_b32 v61, 16, v61
    v_add_f32 v62, 1.0, v62
    v_cvt_pk_bf16_f32 v62, v62, v62
    v_lshlrev_b32 v62, 16, v62
    v_add_f32 v63, 1.0, v63
    v_cvt_pk_bf16_f32 v63, v63, v63
    v_lshlrev_b32 v63, 16, v63
    v_add_f32 v64, 1.0, v64
    v_cvt_pk_bf16_f32 v64, v64, v64
    v_lshlrev_b32 v64, 16, v64
    v_add_f32 v65, 1.0, v65
    v_cvt_pk_bf16_f32 v65, v65, v65
    v_lshlrev_b32 v65, 16, v65
    v_lshlrev_b32 v2, 16, v36
    v_and_b32 v3, s40, v36
    v_fmac_f32 v74, v56, v2
    v_fmac_f32 v75, v56, v3
    v_mul_f32 v2, v61, v2
    v_mul_f32 v3, v61, v3
    v_cvt_pk_bf16_f32 v36, v2, v3
    v_lshlrev_b32 v2, 16, v36
    v_and_b32 v3, s40, v36
    v_add_f32 v66, v66, v2
    v_add_f32 v67, v67, v3
    v_lshlrev_b32 v2, 16, v37
    v_and_b32 v3, s40, v37
    v_fmac_f32 v76, v56, v2
    v_fmac_f32 v77, v56, v3
    v_mul_f32 v2, v61, v2
    v_mul_f32 v3, v61, v3
    v_cvt_pk_bf16_f32 v37, v2, v3
    v_lshlrev_b32 v2, 16, v37
    v_and_b32 v3, s40, v37
    v_add_f32 v68, v68, v2
    v_add_f32 v69, v69, v3
    v_lshlrev_b32 v2, 16, v38
    v_and_b32 v3, s40, v38
    v_fmac_f32 v78, v56, v2
    v_fmac_f32 v79, v56, v3
    v_mul_f32 v2, v61, v2
    v_mul_f32 v3, v61, v3
    v_cvt_pk_bf16_f32 v38, v2, v3
    v_lshlrev_b32 v2, 16, v38
    v_and_b32 v3, s40, v38
    v_add_f32 v70, v70, v2
    v_add_f32 v71, v71, v3
    v_lshlrev_b32 v2, 16, v39
    v_and_b32 v3, s40, v39
    v_fmac_f32 v80, v56, v2
    v_fmac_f32 v81, v56, v3
    v_mul_f32 v2, v61, v2
    v_mul_f32 v3, v61, v3
    v_cvt_pk_bf16_f32 v39, v2, v3
    v_lshlrev_b32 v2, 16, v39
    v_and_b32 v3, s40, v39
    v_add_f32 v72, v72, v2
    v_add_f32 v73, v73, v3
    ds_write_b128 v15, v[36:39] offset:0
    v_lshlrev_b32 v2, 16, v40
    v_and_b32 v3, s40, v40
    v_fmac_f32 v74, v57, v2
    v_fmac_f32 v75, v57, v3
    v_mul_f32 v2, v62, v2
    v_mul_f32 v3, v62, v3
    v_cvt_pk_bf16_f32 v40, v2, v3
    v_lshlrev_b32 v2, 16, v40
    v_and_b32 v3, s40, v40
    v_add_f32 v66, v66, v2
    v_add_f32 v67, v67, v3
    v_lshlrev_b32 v2, 16, v41
    v_and_b32 v3, s40, v41
    v_fmac_f32 v76, v57, v2
    v_fmac_f32 v77, v57, v3
    v_mul_f32 v2, v62, v2
    v_mul_f32 v3, v62, v3
    v_cvt_pk_bf16_f32 v41, v2, v3
    v_lshlrev_b32 v2, 16, v41
    v_and_b32 v3, s40, v41
    v_add_f32 v68, v68, v2
    v_add_f32 v69, v69, v3
    v_lshlrev_b32 v2, 16, v42
    v_and_b32 v3, s40, v42
    v_fmac_f32 v78, v57, v2
    v_fmac_f32 v79, v57, v3
    v_mul_f32 v2, v62, v2
    v_mul_f32 v3, v62, v3
    v_cvt_pk_bf16_f32 v42, v2, v3
    v_lshlrev_b32 v2, 16, v42
    v_and_b32 v3, s40, v42
    v_add_f32 v70, v70, v2
    v_add_f32 v71, v71, v3
    v_lshlrev_b32 v2, 16, v43
    v_and_b32 v3, s40, v43
    v_fmac_f32 v80, v57, v2
    v_fmac_f32 v81, v57, v3
    v_mul_f32 v2, v62, v2
    v_mul_f32 v3, v62, v3
    v_cvt_pk_bf16_f32 v43, v2, v3
    v_lshlrev_b32 v2, 16, v43
    v_and_b32 v3, s40, v43
    v_add_f32 v72, v72, v2
    v_add_f32 v73, v73, v3
    ds_write_b128 v15, v[40:43] offset:5120
    v_lshlrev_b32 v2, 16, v44
    v_and_b32 v3, s40, v44
    v_fmac_f32 v74, v58, v2
    v_fmac_f32 v75, v58, v3
    v_mul_f32 v2, v63, v2
    v_mul_f32 v3, v63, v3
    v_cvt_pk_bf16_f32 v44, v2, v3
    v_lshlrev_b32 v2, 16, v44
    v_and_b32 v3, s40, v44
    v_add_f32 v66, v66, v2
    v_add_f32 v67, v67, v3
    v_lshlrev_b32 v2, 16, v45
    v_and_b32 v3, s40, v45
    v_fmac_f32 v76, v58, v2
    v_fmac_f32 v77, v58, v3
    v_mul_f32 v2, v63, v2
    v_mul_f32 v3, v63, v3
    v_cvt_pk_bf16_f32 v45, v2, v3
    v_lshlrev_b32 v2, 16, v45
    v_and_b32 v3, s40, v45
    v_add_f32 v68, v68, v2
    v_add_f32 v69, v69, v3
    v_lshlrev_b32 v2, 16, v46
    v_and_b32 v3, s40, v46
    v_fmac_f32 v78, v58, v2
    v_fmac_f32 v79, v58, v3
    v_mul_f32 v2, v63, v2
    v_mul_f32 v3, v63, v3
    v_cvt_pk_bf16_f32 v46, v2, v3
    v_lshlrev_b32 v2, 16, v46
    v_and_b32 v3, s40, v46
    v_add_f32 v70, v70, v2
    v_add_f32 v71, v71, v3
    v_lshlrev_b32 v2, 16, v47
    v_and_b32 v3, s40, v47
    v_fmac_f32 v80, v58, v2
    v_fmac_f32 v81, v58, v3
    v_mul_f32 v2, v63, v2
    v_mul_f32 v3, v63, v3
    v_cvt_pk_bf16_f32 v47, v2, v3
    v_lshlrev_b32 v2, 16, v47
    v_and_b32 v3, s40, v47
    v_add_f32 v72, v72, v2
    v_add_f32 v73, v73, v3
    ds_write_b128 v15, v[44:47] offset:10240
    v_lshlrev_b32 v2, 16, v48
    v_and_b32 v3, s40, v48
    v_fmac_f32 v74, v59, v2
    v_fmac_f32 v75, v59, v3
    v_mul_f32 v2, v64, v2
    v_mul_f32 v3, v64, v3
    v_cvt_pk_bf16_f32 v48, v2, v3
    v_lshlrev_b32 v2, 16, v48
    v_and_b32 v3, s40, v48
    v_add_f32 v66, v66, v2
    v_add_f32 v67, v67, v3
    v_lshlrev_b32 v2, 16, v49
    v_and_b32 v3, s40, v49
    v_fmac_f32 v76, v59, v2
    v_fmac_f32 v77, v59, v3
    v_mul_f32 v2, v64, v2
    v_mul_f32 v3, v64, v3
    v_cvt_pk_bf16_f32 v49, v2, v3
    v_lshlrev_b32 v2, 16, v49
    v_and_b32 v3, s40, v49
    v_add_f32 v68, v68, v2
    v_add_f32 v69, v69, v3
    v_lshlrev_b32 v2, 16, v50
    v_and_b32 v3, s40, v50
    v_fmac_f32 v78, v59, v2
    v_fmac_f32 v79, v59, v3
    v_mul_f32 v2, v64, v2
    v_mul_f32 v3, v64, v3
    v_cvt_pk_bf16_f32 v50, v2, v3
    v_lshlrev_b32 v2, 16, v50
    v_and_b32 v3, s40, v50
    v_add_f32 v70, v70, v2
    v_add_f32 v71, v71, v3
    v_lshlrev_b32 v2, 16, v51
    v_and_b32 v3, s40, v51
    v_fmac_f32 v80, v59, v2
    v_fmac_f32 v81, v59, v3
    v_mul_f32 v2, v64, v2
    v_mul_f32 v3, v64, v3
    v_cvt_pk_bf16_f32 v51, v2, v3
    v_lshlrev_b32 v2, 16, v51
    v_and_b32 v3, s40, v51
    v_add_f32 v72, v72, v2
    v_add_f32 v73, v73, v3
    ds_write_b128 v15, v[48:51] offset:15360
    v_lshlrev_b32 v2, 16, v52
    v_and_b32 v3, s40, v52
    v_fmac_f32 v74, v60, v2
    v_fmac_f32 v75, v60, v3
    v_mul_f32 v2, v65, v2
    v_mul_f32 v3, v65, v3
    v_cvt_pk_bf16_f32 v52, v2, v3
    v_lshlrev_b32 v2, 16, v52
    v_and_b32 v3, s40, v52
    v_add_f32 v66, v66, v2
    v_add_f32 v67, v67, v3
    v_lshlrev_b32 v2, 16, v53
    v_and_b32 v3, s40, v53
    v_fmac_f32 v76, v60, v2
    v_fmac_f32 v77, v60, v3
    v_mul_f32 v2, v65, v2
    v_mul_f32 v3, v65, v3
    v_cvt_pk_bf16_f32 v53, v2, v3
    v_lshlrev_b32 v2, 16, v53
    v_and_b32 v3, s40, v53
    v_add_f32 v68, v68, v2
    v_add_f32 v69, v69, v3
    v_lshlrev_b32 v2, 16, v54
    v_and_b32 v3, s40, v54
    v_fmac_f32 v78, v60, v2
    v_fmac_f32 v79, v60, v3
    v_mul_f32 v2, v65, v2
    v_mul_f32 v3, v65, v3
    v_cvt_pk_bf16_f32 v54, v2, v3
    v_lshlrev_b32 v2, 16, v54
    v_and_b32 v3, s40, v54
    v_add_f32 v70, v70, v2
    v_add_f32 v71, v71, v3
    v_lshlrev_b32 v2, 16, v55
    v_and_b32 v3, s40, v55
    v_fmac_f32 v80, v60, v2
    v_fmac_f32 v81, v60, v3
    v_mul_f32 v2, v65, v2
    v_mul_f32 v3, v65, v3
    v_cvt_pk_bf16_f32 v55, v2, v3
    v_lshlrev_b32 v2, 16, v55
    v_and_b32 v3, s40, v55
    v_add_f32 v72, v72, v2
    v_add_f32 v73, v73, v3
    ds_write_b128 v15, v[52:55] offset:20480
    s_nop 1
    v_add_f32_dpp v66, v66, v66 row_ror:8 row_mask:0xf bank_mask:0xf
    v_add_f32_dpp v67, v67, v67 row_ror:8 row_mask:0xf bank_mask:0xf
    v_add_f32_dpp v68, v68, v68 row_ror:8 row_mask:0xf bank_mask:0xf
    v_add_f32_dpp v69, v69, v69 row_ror:8 row_mask:0xf bank_mask:0xf
    v_add_f32_dpp v70, v70, v70 row_ror:8 row_mask:0xf bank_mask:0xf
    v_add_f32_dpp v71, v71, v71 row_ror:8 row_mask:0xf bank_mask:0xf
    v_add_f32_dpp v72, v72, v72 row_ror:8 row_mask:0xf bank_mask:0xf
    v_add_f32_dpp v73, v73, v73 row_ror:8 row_mask:0xf bank_mask:0xf
    v_add_f32_dpp v74, v74, v74 row_ror:8 row_mask:0xf bank_mask:0xf
    v_add_f32_dpp v75, v75, v75 row_ror:8 row_mask:0xf bank_mask:0xf
    v_add_f32_dpp v76, v76, v76 row_ror:8 row_mask:0xf bank_mask:0xf
    v_add_f32_dpp v77, v77, v77 row_ror:8 row_mask:0xf bank_mask:0xf
    v_add_f32_dpp v78, v78, v78 row_ror:8 row_mask:0xf bank_mask:0xf
    v_add_f32_dpp v79, v79, v79 row_ror:8 row_mask:0xf bank_mask:0xf
    v_add_f32_dpp v80, v80, v80 row_ror:8 row_mask:0xf bank_mask:0xf
    v_add_f32_dpp v81, v81, v81 row_ror:8 row_mask:0xf bank_mask:0xf
    v_lshrrev_b32 v2, 4, v0
    v_lshlrev_b32 v2, 8, v2
    v_lshl_add_u32 v2, v14, 5, v2
    ds_write_b128 v2, v[66:69] offset:25600
    ds_write_b128 v2, v[70:73] offset:25616
    ds_write_b128 v2, v[74:77] offset:29696
    ds_write_b128 v2, v[78:81] offset:29712
    v_and_b32 v3, 63, v0
    v_lshrrev_b32 v4, 6, v0
    v_lshlrev_b32 v5, 2, v3
    v_lshl_add_u32 v6, v4, 11, v5
    v_lshrrev_b32 v7, 2, v3
    v_mul_u32_u24 v7, 160, v7
    v_and_b32 v8, 3, v3
    v_lshl_add_u32 v7, v8, 3, v7
    v_lshl_add_u32 v7, v4, 5, v7
    v_readfirstlane_b32 s41, v4
    v_lshlrev_b32 v11, 4, v3
    s_lshr_b32 s42, s29, 6
    s_lshr_b32 s43, s41, 1
    s_add_u32 s43, s43, s42
    s_mul_i32 s43, s43, 43008
    s_and_b32 s41, s41, 1
    s_lshl_b32 s41, s41, 10
    s_add_u32 s43, s43, s41
    s_mul_i32 s41, s28, 10240
    s_add_u32 s43, s43, s41
    s_waitcnt lgkmcnt(0)
    s_barrier
    ds_read_b32 v16, v6 offset:25600
    ds_read_b32 v17, v6 offset:25856
    ds_read_b32 v18, v6 offset:26112
    ds_read_b32 v19, v6 offset:26368
    ds_read_b32 v20, v6 offset:26624
    ds_read_b32 v21, v6 offset:26880
    ds_read_b32 v22, v6 offset:27136
    ds_read_b32 v23, v6 offset:27392
    ds_read_b64_tr_b16 v[36:37], v7 offset:0
    ds_read_b64_tr_b16 v[38:39], v7 offset:2560
    ds_read_b64_tr_b16 v[40:41], v7 offset:5120
    ds_read_b64_tr_b16 v[42:43], v7 offset:7680
    ds_read_b64_tr_b16 v[44:45], v7 offset:10240
    ds_read_b64_tr_b16 v[46:47], v7 offset:12800
    ds_read_b64_tr_b16 v[48:49], v7 offset:15360
    ds_read_b64_tr_b16 v[50:51], v7 offset:17920
    ds_read_b64_tr_b16 v[52:53], v7 offset:20480
    ds_read_b64_tr_b16 v[54:55], v7 offset:23040
    v_lshlrev_b32 v12, 2, v0
    v_lshrrev_b32 v8, 1, v4
    v_lshl_add_u32 v9, v8, 9, v5
    v_and_b32 v10, 1, v4
    s_lshl_b32 s44, s28, 1
    v_lshl_add_u32 v8, v8, 3, v10
    v_add_u32 v8, s44, v8
    v_lshrrev_b32 v24, 2, v8
    v_lshlrev_b32 v24, 8, v24
    v_and_b32 v8, 3, v8
    v_lshl_add_u32 v8, v8, 1, v24
    v_and_b32 v24, 15, v3
    v_lshl_add_u32 v8, v24, 4, v8
    v_bfe_u32 v24, v3, 4, 1
    v_lshl_add_u32 v8, v24, 10, v8
    v_lshrrev_b32 v24, 5, v3
    v_mul_u32_u24 v24, 43008, v24
    v_add_u32 v8, v8, v24
    s_mul_i32 s44, s42, 43008
    s_add_u32 s44, s44, 40960
    v_cmp_eq_u32 vcc, 1, v10
    s_waitcnt lgkmcnt(10)
    v_add_f32 v16, v16, v20
    v_add_f32 v17, v17, v21
    v_add_f32 v18, v18, v22
    v_add_f32 v19, v19, v23
    v_add_f32 v16, v16, v18
    v_add_f32 v17, v17, v19
    v_add_f32 v16, v16, v17
    ds_write_b32 v12, v16 offset:33792
    s_waitcnt lgkmcnt(9)
    s_add_u32 s23, s43, 0
    buffer_store_dwordx4 v[36:39], v11, s[32:35], s23 offen sc0 sc1
    s_waitcnt lgkmcnt(7)
    s_add_u32 s23, s43, 2048
    buffer_store_dwordx4 v[40:43], v11, s[32:35], s23 offen sc0 sc1
    s_waitcnt lgkmcnt(5)
    s_add_u32 s23, s43, 4096
    buffer_store_dwordx4 v[44:47], v11, s[32:35], s23 offen sc0 sc1
    s_waitcnt lgkmcnt(3)
    s_add_u32 s23, s43, 6144
    buffer_store_dwordx4 v[48:51], v11, s[32:35], s23 offen sc0 sc1
    s_waitcnt lgkmcnt(1)
    s_add_u32 s23, s43, 8192
    buffer_store_dwordx4 v[52:55], v11, s[32:35], s23 offen sc0 sc1
    s_waitcnt lgkmcnt(0)
    s_barrier
    ds_read_b32 v16, v9 offset:33792
    ds_read_b32 v17, v9 offset:34048
    s_waitcnt lgkmcnt(0)
    v_add_f32 v16, v16, v17
    v_cvt_pk_bf16_f32 v17, v16, v16
    v_lshlrev_b32 v18, 16, v17
    v_sub_f32 v16, v16, v18
    v_cvt_pk_bf16_f32 v16, v16, v16
    v_cndmask_b32 v16, v17, v16, vcc
    buffer_store_short v16, v8, s[32:35], s44 offen
    s_endpgm
pc_g:
    s_cmp_ge_u32 s2, 118
    s_cbranch_scc1 pc_done
    s_load_dwordx4 s[16:19], s[0:1], 120
    s_memrealtime s[56:57]
    v_and_b32 v1, 63, v0
    v_and_b32 v2, 3, v0
    v_mul_u32_u24 v2, 61440, v2
    v_lshrrev_b32 v3, 2, v0
    v_lshl_add_u32 v2, v3, 4, v2
    v_lshlrev_b32 v3, 2, v3
    s_sub_u32 s20, s2, 108
    s_lshl_b32 s21, s20, 8
    s_add_u32 s21, s21, 12800
    s_lshl_b32 s20, s21, 2
    s_mov_b32 s60, 4194304
    s_mov_b32 s61, 0
    s_waitcnt lgkmcnt(0)
    s_mov_b32 s24, s18
    s_mov_b32 s25, s19
    s_mov_b32 s26, 15360
    s_mov_b32 s27, 0x00020000
    s_mov_b32 s48, s16
    s_mov_b32 s49, s17
    s_mov_b32 s50, 256
    s_mov_b32 s51, 0x00020000
    s_add_u32 s52, s18, 5636096
    s_addc_u32 s53, s19, 0
    s_mov_b32 s54, 245760
    s_mov_b32 s55, 0x00020000
    v_mov_b32 v6, s56
    v_mov_b32 v7, s57
    v_subrev_co_u32 v6, vcc, 200, v6
    v_subbrev_co_u32 v7, vcc, 0, v7, vcc
    s_add_u32 s28, s18, 11042816
    s_addc_u32 s29, s19, 0
    s_mov_b32 s30, 65536
    s_mov_b32 s31, 0x00020000
    s_sub_u32 s22, s2, 108
    s_lshl_b32 s22, s22, 13
    v_lshlrev_b32 v12, 4, v0
    v_mov_b32 v8, 0
    v_mov_b32 v9, 0
    v_mov_b32 v10, 0
    v_mov_b32 v11, 0
    buffer_store_dwordx4 v[8:11], v12, s[28:31], s22 offen
    s_add_u32 s22, s22, 4096
    buffer_store_dwordx4 v[8:11], v12, s[28:31], s22 offen
    s_add_u32 s22, s22, 4096
    s_waitcnt vmcnt(0)
    s_mov_b32 s46, 0
gq_gate:
    s_memrealtime s[44:45]
    s_add_u32 s46, s46, 1
    s_waitcnt lgkmcnt(0)
    s_sub_u32 s44, s44, s56
    s_cmp_ge_u32 s44, 410
    s_cbranch_scc1 gq_gate_e
    s_sleep 16
    s_cmp_lt_u32 s46, 256
    s_cbranch_scc1 gq_gate
gq_gate_e:
    s_mov_b32 s44, 0
    buffer_load_dwordx4 v[8:11], v2, s[52:55], s20 offen
    s_branch gq_t
gq_loop:
    s_and_b32 s46, s44, 3
    s_cmp_eq_u32 s46, 3
    s_cbranch_scc1 gq_t0
    buffer_load_dwordx4 v[8:11], v2, s[52:55], s20 offen sc1
    s_branch gq_t
gq_t0:
    buffer_load_dwordx2 v[12:13], off, s[48:51], 0 offset:32 sc1
    buffer_load_dwordx4 v[8:11], v2, s[52:55], s20 offen sc1
    s_waitcnt vmcnt(1)
    v_not_b32 v12, v12
    v_not_b32 v13, v13
    v_cmp_lt_u64 vcc, v[12:13], v[6:7]
    s_nop 1
    v_cndmask_b32 v6, v6, v12, vcc
    v_cndmask_b32 v7, v7, v13, vcc
gq_t:
    s_waitcnt vmcnt(0)
    v_sub_co_u32 v8, vcc, v8, v6
    v_subb_co_u32 v9, vcc, v9, v7, vcc
    v_cmp_gt_u64 s[46:47], s[60:61], v[8:9]
    s_cmp_eq_u64 s[46:47], -1
    s_cbranch_scc1 gq_ok
    s_add_u32 s44, s44, 1
    s_cmp_eq_u32 s44, 1
    s_cbranch_scc1 gq_loop
    s_sleep 16
    s_and_b32 s46, s44, 15
    s_cbranch_scc1 gq_next
    s_mov_b64 exec, 15
    v_lshlrev_b32 v8, 6, v1
    buffer_load_dword v8, v8, s[48:51], 0 offen sc1
    s_waitcnt vmcnt(0)
    v_cmp_eq_u32 vcc, 64, v8
    s_mov_b64 exec, -1
    s_cmp_eq_u32 vcc_lo, 15
    s_cbranch_scc0 gq_next
    buffer_load_dwordx4 v[8:11], v2, s[52:55], s20 offen sc1
    s_waitcnt vmcnt(0)
    s_branch gq_ok
gq_next:
    s_cmp_lt_u32 s44, 32768
    s_cbranch_scc1 gq_loop
gq_ok:
    s_nop 1
    v_add_f32_dpp v10, v10, v10 quad_perm:[1,0,3,2] row_mask:0xf bank_mask:0xf
    s_nop 1
    v_add_f32_dpp v10, v10, v10 quad_perm:[2,3,0,1] row_mask:0xf bank_mask:0xf
    v_cvt_pk_bf16_f32 v10, v10, v10
    v_lshlrev_b32 v10, 16, v10
    s_mov_b32 exec_lo, 0x11111111
    s_mov_b32 exec_hi, 0x11111111
    buffer_store_dword v10, v3, s[24:27], s21 offen
    s_endpgm
pc_k:
    s_sub_u32 s2, s2, 256
    s_cmp_ge_u32 s2, 640
    s_cbranch_scc1 pc_h
    s_setprio 3
    s_and_b32 s20, s2, 7
    s_lshl_b32 s20, s20, 3
    s_bfe_u32 s21, s2, 0x30003
    s_andn2_b32 s86, s2, 63
    s_add_u32 s86, s86, s20
    s_add_u32 s86, s86, s21
    s_setreg_imm32_b32 hwreg(HW_REG_MODE, 9, 1), 0
    v_and_b32 v1, 63, v0
    v_lshrrev_b32 v2, 6, v0
    v_and_b32 v5, 31, v0
    v_lshl_add_u32 v5, v2, 5, v5
    v_lshlrev_b32 v6, 1, v5
    s_lshl_b32 s3, s86, 8
    s_lshl_b32 s22, s86, 1
    v_mov_b32 v7, 0
    v_readfirstlane_b32 s87, v2
    v_add_u32 v6, s3, v6
    v_mov_b32 v7, s22
    s_waitcnt lgkmcnt(0)
    global_load_ushort v8, v6, s[4:5]
    global_load_ushort v9, v6, s[6:7]
    global_load_ushort v10, v6, s[8:9]
    global_load_ushort v11, v6, s[10:11]
    global_load_ushort v12, v6, s[12:13]
    global_load_ushort v13, v6, s[14:15]
    global_load_ushort v7, v7, s[16:17]
    s_and_b32 s52, s22, 0xfffffffc
    s_add_u32 s52, s18, s52
    s_addc_u32 s53, s19, 0
    s_load_dword s58, s[52:53], 0
    v_lshlrev_b32 v111, 4, v0
    s_mul_i32 s3, s86, 4352
    s_add_u32 s64, s62, 2850816
    s_addc_u32 s65, s63, 0
    s_mov_b32 s66, 8192
    s_mov_b32 s67, 0x00020000
    s_add_u32 s68, s62, 65536
    s_addc_u32 s69, s63, 0
    s_mov_b32 s70, 2621440
    s_mov_b32 s71, 0x00020000
    s_add_u32 s72, s3, 8257536
    s_add_u32 s72, s62, s72
    s_addc_u32 s73, s63, 0
    s_mov_b32 s74, 4096
    s_mov_b32 s75, 0x00020000
    s_add_u32 s76, s62, 5636096
    s_addc_u32 s77, s63, 0
    s_mov_b32 s78, 245760
    s_mov_b32 s79, 0x00020000
    s_mov_b32 s80, s60
    s_mov_b32 s81, s61
    s_mov_b32 s82, 256
    s_mov_b32 s83, 0x00020000
    s_add_u32 s8, s62, 32768
    s_addc_u32 s9, s63, 0
    s_mov_b32 s10, 32768
    s_mov_b32 s11, 0x00020000
    s_lshr_b32 s20, s2, 3
    s_and_b32 s20, s20, 15
    s_lshl_b32 s20, s20, 11
    v_lshlrev_b32 v127, 5, v0
    v_mul_u32_u24 v126, 10240, v0
    v_min_u32 v110, 11, v1
    v_and_b32 v112, 3, v110
    v_mul_u32_u24 v112, 61440, v112
    v_lshrrev_b32 v110, 2, v110
    v_mul_u32_u24 v110, 10240, v110
    v_add_u32 v110, v110, v112
    v_mov_b32 v108, s54
    v_mov_b32 v109, s55
    v_subrev_co_u32 v108, vcc, 200, v108
    v_subbrev_co_u32 v109, vcc, 0, v109, vcc
    s_lshl_b32 s23, s86, 4
    s_mov_b32 s4, 4194304
    s_mov_b32 s5, 0
    s_mov_b32 s56, 1069066811
    s_mov_b32 s57, 1042479491
    v_and_b32 v3, 15, v1
    v_lshrrev_b32 v4, 4, v1
    v_cvt_f32_u32 v16, v3
    v_mul_u32_u24 v5, 80, v5
    v_lshrrev_b32 v14, 5, v1
    v_lshl_add_u32 v23, v14, 5, v5
    v_cvt_f32_u32 v14, v14
    v_mul_f32 v15, 1145044992, v14
    v_add_f32 v19, 1132462080, v15
    v_add_f32 v20, 1140326400, v15
    v_mul_f32 v15, 1144815616, v14
    v_add_f32 v21, 1144750080, v15
    v_mul_f32 v15, 3278897152, v14
    v_add_f32 v22, 1157103616, v15
    v_lshl_add_u32 v6, v2, 5, v4
    v_mul_u32_u24 v6, 80, v6
    v_cmp_gt_u32 vcc, 8, v3
    v_and_b32 v14, 1, v3
    v_lshl_add_u32 v14, v14, 3, 8
    v_cndmask_b32 v14, v14, 0, vcc
    v_add_u32 v17, v6, v14
    v_lshrrev_b32 v14, 1, v3
    v_lshl_add_u32 v14, v14, 3, 32
    v_cndmask_b32 v14, 24, v14, vcc
    v_add_u32 v18, v6, v14
    v_mul_u32_u24 v14, 3072, v2
    v_add_u32 v14, 16640, v14
    v_lshl_add_u32 v15, v3, 2, v4
    v_lshl_add_u32 v24, v15, 4, v14
    v_lshl_add_u32 v15, v3, 1, v4
    v_lshl_add_u32 v15, v15, 3, v14
    v_cmp_gt_u32 vcc, 2, v4
    v_mov_b32 v28, 1264
    v_mov_b32 v29, 1024
    v_cndmask_b32 v28, v28, v29, vcc
    v_add_u32 v25, v15, v28
    v_mov_b32 v28, 1520
    v_mov_b32 v29, 2816
    v_cndmask_b32 v28, v28, v29, vcc
    v_add_u32 v26, v15, v28
    v_lshl_add_u32 v15, v4, 5, v3
    v_lshl_add_u32 v15, v15, 3, v14
    v_add_u32 v27, 1792, v15
    s_waitcnt vmcnt(0)
    v_lshlrev_b32 v7, 16, v7
    v_mul_f32 v7, s56, v7
    v_exp_f32 v7, v7
    v_lshlrev_b32 v8, 16, v8
    v_lshlrev_b32 v9, 16, v9
    v_lshlrev_b32 v10, 16, v10
    v_lshlrev_b32 v11, 16, v11
    v_lshlrev_b32 v12, 16, v12
    v_lshlrev_b32 v13, 16, v13
    v_cvt_pk_bf16_f32 v7, v7, v7
    v_lshlrev_b32 v7, 16, v7
    v_mul_f32 v8, v7, v8
    v_mul_f32 v9, v7, v9
    v_mul_f32 v14, v13, v11
    v_fma_f32 v46, v12, v10, -v14
    v_mul_f32 v14, v13, v10
    v_fma_f32 v47, v12, v11, v14
    v_mul_f32 v44, s56, v8
    v_mul_f32 v45, s57, v9
    v_rndne_f32 v15, v45
    v_sub_f32 v45, v45, v15
    v_max_f32 v14, |v46|, |v47|
    v_mul_f32 v64, v45, v19
    v_mul_f32 v65, v45, v20
    v_mul_f32 v66, v45, v21
    v_mul_f32 v67, v45, v22
    v_mul_f32 v60, v44, v19
    v_mul_f32 v61, v44, v20
    v_mul_f32 v62, v44, v21
    v_mul_f32 v63, v44, v22
    v_fract_f32 v64, v64
    v_fract_f32 v65, v65
    v_fract_f32 v66, v66
    v_fract_f32 v67, v67
    v_exp_f32 v60, v60
    v_exp_f32 v61, v61
    v_max_f32_dpp v14, v14, v14 quad_perm:[1,0,3,2] row_mask:0xf bank_mask:0xf
    v_exp_f32 v62, v62
    v_exp_f32 v63, v63
    v_max_f32_dpp v14, v14, v14 quad_perm:[2,3,0,1] row_mask:0xf bank_mask:0xf
    v_sin_f32 v68, v64
    v_sin_f32 v69, v65
    v_max_f32_dpp v14, v14, v14 row_half_mirror row_mask:0xf bank_mask:0xf
    v_sin_f32 v70, v66
    v_sin_f32 v71, v67
    v_max_f32_dpp v14, v14, v14 row_mirror row_mask:0xf bank_mask:0xf
    v_cos_f32 v64, v64
    v_cos_f32 v65, v65
    v_mov_b32 v15, v14
    v_cos_f32 v66, v66
    v_cos_f32 v67, v67
    v_permlane16_swap_b32 v14, v15
    v_mul_f32 v73, v60, v68
    v_mul_f32 v75, v61, v69
    v_max_f32 v14, v14, v15
    v_mul_f32 v77, v62, v70
    v_mul_f32 v79, v63, v71
    v_mov_b32 v15, v14
    v_mul_f32 v72, v60, v64
    v_mul_f32 v74, v61, v65
    v_permlane32_swap_b32 v14, v15
    v_mul_f32 v76, v62, v66
    v_mul_f32 v78, v63, v67
    v_max_f32 v14, v14, v15
    ds_write_b128 v23, v[72:75] offset:16
    ds_write_b128 v23, v[76:79] offset:32
    v_lshlrev_b32 v15, 2, v2
    ds_write_b32 v15, v14 offset:28928
    v_lshrrev_b32 v30, 23, v14
    v_max_u32 v30, 15, v30
    v_min_u32 v30, 0xfe, v30
    v_sub_u32 v15, 0x10c, v30
    v_lshlrev_b32 v15, 23, v15
    v_subrev_u32 v30, 14, v30
    v_lshlrev_b32 v30, 23, v30
    v_mul_f32 v46, v46, v15
    v_mul_f32 v47, v47, v15
    ds_write_b128 v5, v[44:47] offset:0
    s_waitcnt lgkmcnt(0)
    ds_read_b128 v[44:47], v6 offset:0
    ds_read_b64 v[48:49], v17 offset:16
    ds_read_b64 v[50:51], v18 offset:16
    ds_read_b128 v[52:55], v6 offset:320
    ds_read_b64 v[56:57], v17 offset:336
    ds_read_b64 v[58:59], v18 offset:336
    s_waitcnt lgkmcnt(3)
    v_mul_f32 v60, v44, v16
    v_mul_f32 v61, v45, v16
    v_exp_f32 v60, v60
    v_sin_f32 v62, v61
    v_cos_f32 v61, v61
    v_mul_f32 v65, v60, v62
    v_mul_f32 v64, v60, v61
    v_mul_f32 v63, v65, v65
    v_mul_f32 v67, v64, v65 mul:2
    v_fma_f32 v66, v64, v64, -v63
    v_cvt_pk_f16_f32 v76, v64, v65
    v_mul_f32 v63, v67, v67
    v_mul_f32 v69, v66, v67 mul:2
    v_fma_f32 v68, v66, v66, -v63
    v_mul_f32 v60, v67, v49
    v_mul_f32 v62, v67, v48
    v_fma_f32 v74, v66, v48, -v60
    v_fma_f32 v75, v66, v49, v62
    v_cvt_pk_f16_f32 v80, v74, v75
    v_mul_f32 v63, v69, v69
    v_mul_f32 v71, v68, v69 mul:2
    v_fma_f32 v70, v68, v68, -v63
    v_mul_f32 v63, v71, v71
    v_mul_f32 v73, v70, v71 mul:2
    v_fma_f32 v72, v70, v70, -v63
    v_mul_f32 v60, v71, v51
    v_mul_f32 v62, v71, v50
    v_fma_f32 v74, v70, v50, -v60
    v_fma_f32 v75, v70, v51, v62
    v_cvt_pk_f16_f32 v84, v74, v75
    v_mul_f32 v60, v47, v73
    v_mul_f32 v62, v47, v72
    v_fma_f32 v74, v46, v72, -v60
    v_fma_f32 v75, -v46, v73, -v62
    ds_read_b128 v[44:47], v6 offset:640
    ds_read_b64 v[48:49], v17 offset:656
    ds_read_b64 v[50:51], v18 offset:656
    v_cvt_pk_f16_f32 v100, v74, v75
    s_waitcnt lgkmcnt(3)
    v_mul_f32 v60, v52, v16
    v_mul_f32 v61, v53, v16
    v_exp_f32 v60, v60
    v_sin_f32 v62, v61
    v_cos_f32 v61, v61
    v_mul_f32 v65, v60, v62
    v_mul_f32 v64, v60, v61
    v_mul_f32 v63, v65, v65
    v_mul_f32 v67, v64, v65 mul:2
    v_fma_f32 v66, v64, v64, -v63
    v_cvt_pk_f16_f32 v77, v64, v65
    v_mul_f32 v63, v67, v67
    v_mul_f32 v69, v66, v67 mul:2
    v_fma_f32 v68, v66, v66, -v63
    v_mul_f32 v60, v67, v57
    v_mul_f32 v62, v67, v56
    v_fma_f32 v74, v66, v56, -v60
    v_fma_f32 v75, v66, v57, v62
    v_cvt_pk_f16_f32 v81, v74, v75
    v_mul_f32 v63, v69, v69
    v_mul_f32 v71, v68, v69 mul:2
    v_fma_f32 v70, v68, v68, -v63
    v_mul_f32 v63, v71, v71
    v_mul_f32 v73, v70, v71 mul:2
    v_fma_f32 v72, v70, v70, -v63
    v_mul_f32 v60, v71, v59
    v_mul_f32 v62, v71, v58
    v_fma_f32 v74, v70, v58, -v60
    v_fma_f32 v75, v70, v59, v62
    v_cvt_pk_f16_f32 v85, v74, v75
    v_mul_f32 v60, v55, v73
    v_mul_f32 v62, v55, v72
    v_fma_f32 v74, v54, v72, -v60
    v_fma_f32 v75, -v54, v73, -v62
    ds_read_b128 v[52:55], v6 offset:960
    ds_read_b64 v[56:57], v17 offset:976
    ds_read_b64 v[58:59], v18 offset:976
    v_cvt_pk_f16_f32 v101, v74, v75
    s_waitcnt lgkmcnt(3)
    v_mul_f32 v60, v44, v16
    v_mul_f32 v61, v45, v16
    v_exp_f32 v60, v60
    v_sin_f32 v62, v61
    v_cos_f32 v61, v61
    v_mul_f32 v65, v60, v62
    v_mul_f32 v64, v60, v61
    v_mul_f32 v63, v65, v65
    v_mul_f32 v67, v64, v65 mul:2
    v_fma_f32 v66, v64, v64, -v63
    v_cvt_pk_f16_f32 v78, v64, v65
    v_mul_f32 v63, v67, v67
    v_mul_f32 v69, v66, v67 mul:2
    v_fma_f32 v68, v66, v66, -v63
    v_mul_f32 v60, v67, v49
    v_mul_f32 v62, v67, v48
    v_fma_f32 v74, v66, v48, -v60
    v_fma_f32 v75, v66, v49, v62
    v_cvt_pk_f16_f32 v82, v74, v75
    v_mul_f32 v63, v69, v69
    v_mul_f32 v71, v68, v69 mul:2
    v_fma_f32 v70, v68, v68, -v63
    v_mul_f32 v63, v71, v71
    v_mul_f32 v73, v70, v71 mul:2
    v_fma_f32 v72, v70, v70, -v63
    v_mul_f32 v60, v71, v51
    v_mul_f32 v62, v71, v50
    v_fma_f32 v74, v70, v50, -v60
    v_fma_f32 v75, v70, v51, v62
    v_cvt_pk_f16_f32 v86, v74, v75
    v_mul_f32 v60, v47, v73
    v_mul_f32 v62, v47, v72
    v_fma_f32 v74, v46, v72, -v60
    v_fma_f32 v75, -v46, v73, -v62
    ds_read_b128 v[44:47], v6 offset:1280
    ds_read_b64 v[48:49], v17 offset:1296
    ds_read_b64 v[50:51], v18 offset:1296
    v_cvt_pk_f16_f32 v102, v74, v75
    s_setprio 2
    s_waitcnt lgkmcnt(3)
    v_mul_f32 v60, v52, v16
    v_mul_f32 v61, v53, v16
    v_exp_f32 v60, v60
    v_sin_f32 v62, v61
    v_cos_f32 v61, v61
    v_mul_f32 v65, v60, v62
    v_mul_f32 v64, v60, v61
    v_mul_f32 v63, v65, v65
    v_mul_f32 v67, v64, v65 mul:2
    v_fma_f32 v66, v64, v64, -v63
    v_cvt_pk_f16_f32 v79, v64, v65
    v_mul_f32 v63, v67, v67
    v_mul_f32 v69, v66, v67 mul:2
    v_fma_f32 v68, v66, v66, -v63
    v_mul_f32 v60, v67, v57
    v_mul_f32 v62, v67, v56
    v_fma_f32 v74, v66, v56, -v60
    v_fma_f32 v75, v66, v57, v62
    v_cvt_pk_f16_f32 v83, v74, v75
    v_mul_f32 v63, v69, v69
    v_mul_f32 v71, v68, v69 mul:2
    v_fma_f32 v70, v68, v68, -v63
    v_mul_f32 v63, v71, v71
    v_mul_f32 v73, v70, v71 mul:2
    v_fma_f32 v72, v70, v70, -v63
    v_mul_f32 v60, v71, v59
    v_mul_f32 v62, v71, v58
    v_fma_f32 v74, v70, v58, -v60
    v_fma_f32 v75, v70, v59, v62
    v_cvt_pk_f16_f32 v87, v74, v75
    v_mul_f32 v60, v55, v73
    v_mul_f32 v62, v55, v72
    v_fma_f32 v74, v54, v72, -v60
    v_fma_f32 v75, -v54, v73, -v62
    ds_read_b128 v[52:55], v6 offset:1600
    ds_read_b64 v[56:57], v17 offset:1616
    ds_read_b64 v[58:59], v18 offset:1616
    v_cvt_pk_f16_f32 v103, v74, v75
    s_waitcnt lgkmcnt(3)
    v_mul_f32 v60, v44, v16
    v_mul_f32 v61, v45, v16
    v_exp_f32 v60, v60
    v_mfma_f32_16x16x32_f16 v[32:35], v[76:79], v[100:103], 0
    v_sin_f32 v62, v61
    v_cos_f32 v61, v61
    v_mul_f32 v65, v60, v62
    v_mul_f32 v64, v60, v61
    v_mfma_f32_16x16x32_f16 v[36:39], v[80:83], v[100:103], 0
    v_mul_f32 v63, v65, v65
    v_mul_f32 v67, v64, v65 mul:2
    v_fma_f32 v66, v64, v64, -v63
    v_cvt_pk_f16_f32 v88, v64, v65
    v_mfma_f32_16x16x32_f16 v[40:43], v[84:87], v[100:103], 0
    v_mul_f32 v63, v67, v67
    v_mul_f32 v69, v66, v67 mul:2
    v_fma_f32 v68, v66, v66, -v63
    v_mul_f32 v60, v67, v49
    v_mul_f32 v62, v67, v48
    v_fma_f32 v74, v66, v48, -v60
    v_fma_f32 v75, v66, v49, v62
    v_cvt_pk_f16_f32 v92, v74, v75
    v_mul_f32 v63, v69, v69
    v_mul_f32 v71, v68, v69 mul:2
    v_fma_f32 v70, v68, v68, -v63
    v_mul_f32 v63, v71, v71
    v_mul_f32 v73, v70, v71 mul:2
    v_fma_f32 v72, v70, v70, -v63
    v_mul_f32 v60, v71, v51
    v_mul_f32 v62, v71, v50
    v_fma_f32 v74, v70, v50, -v60
    v_fma_f32 v75, v70, v51, v62
    v_cvt_pk_f16_f32 v96, v74, v75
    v_mul_f32 v60, v47, v73
    v_mul_f32 v62, v47, v72
    v_fma_f32 v74, v46, v72, -v60
    v_fma_f32 v75, -v46, v73, -v62
    ds_read_b128 v[44:47], v6 offset:1920
    ds_read_b64 v[48:49], v17 offset:1936
    ds_read_b64 v[50:51], v18 offset:1936
    v_cvt_pk_f16_f32 v104, v74, v75
    s_memrealtime s[12:13]
    s_mov_b32 s21, 0
    s_waitcnt lgkmcnt(3)
    v_mul_f32 v60, v52, v16
    v_mul_f32 v61, v53, v16
    v_exp_f32 v60, v60
    v_sin_f32 v62, v61
    v_cos_f32 v61, v61
    v_mul_f32 v65, v60, v62
    v_mul_f32 v64, v60, v61
    v_mul_f32 v63, v65, v65
    v_mul_f32 v67, v64, v65 mul:2
    v_fma_f32 v66, v64, v64, -v63
    v_cvt_pk_f16_f32 v89, v64, v65
    v_mul_f32 v63, v67, v67
    v_mul_f32 v69, v66, v67 mul:2
    v_fma_f32 v68, v66, v66, -v63
    v_mul_f32 v60, v67, v57
    v_mul_f32 v62, v67, v56
    v_fma_f32 v74, v66, v56, -v60
    v_fma_f32 v75, v66, v57, v62
    v_cvt_pk_f16_f32 v93, v74, v75
    v_mul_f32 v63, v69, v69
    v_mul_f32 v71, v68, v69 mul:2
    v_fma_f32 v70, v68, v68, -v63
    v_mul_f32 v63, v71, v71
    v_mul_f32 v73, v70, v71 mul:2
    v_fma_f32 v72, v70, v70, -v63
    v_mul_f32 v60, v71, v59
    v_mul_f32 v62, v71, v58
    v_fma_f32 v74, v70, v58, -v60
    v_fma_f32 v75, v70, v59, v62
    v_cvt_pk_f16_f32 v97, v74, v75
    v_mul_f32 v60, v55, v73
    v_mul_f32 v62, v55, v72
    v_fma_f32 v74, v54, v72, -v60
    v_fma_f32 v75, -v54, v73, -v62
    ds_read_b128 v[52:55], v6 offset:2240
    ds_read_b64 v[56:57], v17 offset:2256
    ds_read_b64 v[58:59], v18 offset:2256
    v_cvt_pk_f16_f32 v105, v74, v75
    s_setprio 1
    s_waitcnt lgkmcnt(0)
    s_bfe_u32 s20, s12, 262148
    s_lshl_b32 s20, s20, 11
    s_sub_u32 s12, s12, s54
    s_cmp_lt_u32 s12, 250
    s_cbranch_scc1 kc_h1
    v_lshrrev_b32 v112, 1, v111
    buffer_load_dwordx2 v[112:113], v112, s[8:11], s20 offen
    s_mov_b32 s21, 1
kc_h1:
    s_waitcnt lgkmcnt(3)
    v_mul_f32 v60, v44, v16
    v_mul_f32 v61, v45, v16
    v_exp_f32 v60, v60
    v_sin_f32 v62, v61
    v_cos_f32 v61, v61
    v_mul_f32 v65, v60, v62
    v_mul_f32 v64, v60, v61
    v_mul_f32 v63, v65, v65
    v_mul_f32 v67, v64, v65 mul:2
    v_fma_f32 v66, v64, v64, -v63
    v_cvt_pk_f16_f32 v90, v64, v65
    v_mul_f32 v63, v67, v67
    v_mul_f32 v69, v66, v67 mul:2
    v_fma_f32 v68, v66, v66, -v63
    v_mul_f32 v60, v67, v49
    v_mul_f32 v62, v67, v48
    v_fma_f32 v74, v66, v48, -v60
    v_fma_f32 v75, v66, v49, v62
    v_cvt_pk_f16_f32 v94, v74, v75
    v_mul_f32 v63, v69, v69
    v_mul_f32 v71, v68, v69 mul:2
    v_fma_f32 v70, v68, v68, -v63
    v_mul_f32 v63, v71, v71
    v_mul_f32 v73, v70, v71 mul:2
    v_fma_f32 v72, v70, v70, -v63
    v_mul_f32 v60, v71, v51
    v_mul_f32 v62, v71, v50
    v_fma_f32 v74, v70, v50, -v60
    v_fma_f32 v75, v70, v51, v62
    v_cvt_pk_f16_f32 v98, v74, v75
    v_mul_f32 v60, v47, v73
    v_mul_f32 v62, v47, v72
    v_fma_f32 v74, v46, v72, -v60
    v_fma_f32 v75, -v46, v73, -v62
    v_cvt_pk_f16_f32 v106, v74, v75
    s_waitcnt lgkmcnt(0)
    v_mul_f32 v60, v52, v16
    v_mul_f32 v61, v53, v16
    v_exp_f32 v60, v60
    v_sin_f32 v62, v61
    v_cos_f32 v61, v61
    v_mul_f32 v65, v60, v62
    v_mul_f32 v64, v60, v61
    v_mul_f32 v63, v65, v65
    v_mul_f32 v67, v64, v65 mul:2
    v_fma_f32 v66, v64, v64, -v63
    v_cvt_pk_f16_f32 v91, v64, v65
    v_mul_f32 v63, v67, v67
    v_mul_f32 v69, v66, v67 mul:2
    v_fma_f32 v68, v66, v66, -v63
    v_mul_f32 v60, v67, v57
    v_mul_f32 v62, v67, v56
    v_fma_f32 v74, v66, v56, -v60
    v_fma_f32 v75, v66, v57, v62
    v_cvt_pk_f16_f32 v95, v74, v75
    v_mul_f32 v63, v69, v69
    v_mul_f32 v71, v68, v69 mul:2
    v_fma_f32 v70, v68, v68, -v63
    v_mul_f32 v63, v71, v71
    v_mul_f32 v73, v70, v71 mul:2
    v_fma_f32 v72, v70, v70, -v63
    v_mul_f32 v60, v71, v59
    v_mul_f32 v62, v71, v58
    v_fma_f32 v74, v70, v58, -v60
    v_fma_f32 v75, v70, v59, v62
    v_cvt_pk_f16_f32 v99, v74, v75
    v_mul_f32 v60, v55, v73
    v_mul_f32 v62, v55, v72
    v_fma_f32 v74, v54, v72, -v60
    v_fma_f32 v75, -v54, v73, -v62
    v_cvt_pk_f16_f32 v107, v74, v75
    s_nop 1
    v_mfma_f32_16x16x32_f16 v[32:35], v[88:91], v[104:107], v[32:35]
    v_mfma_f32_16x16x32_f16 v[36:39], v[92:95], v[104:107], v[36:39]
    v_mfma_f32_16x16x32_f16 v[40:43], v[96:99], v[104:107], v[40:43]
    v_lshlrev_b32 v17, 6, v2
    v_lshl_add_u32 v18, v4, 4, v17
    v_lshrrev_b32 v5, 2, v3
    v_lshlrev_b32 v5, 3, v5
    v_sub_u32 v6, v18, v5
    v_and_b32 v5, 3, v3
    v_mul_u32_u24 v5, 4160, v5
    v_sub_u32 v5, 12504, v5
    v_add_u32 v6, v6, v5
    v_lshl_add_u32 v16, v3, 5, v18
    v_mul_f32 v32, v32, v30
    v_mul_f32 v33, v33, v30
    v_mul_f32 v34, v34, v30
    v_mul_f32 v35, v35, v30
    v_mul_f32 v36, v36, v30
    v_mul_f32 v37, v37, v30
    v_mul_f32 v38, v38, v30
    v_mul_f32 v39, v39, v30
    v_mul_f32 v40, v40, v30
    v_mul_f32 v41, v41, v30
    v_mul_f32 v42, v42, v30
    v_mul_f32 v43, v43, v30
    ds_write_b128 v24, v[32:35]
    ds_write2_b32 v25, v36, v38 offset0:0 offset1:1
    ds_write2_b32 v26, v37, v39 offset0:0 offset1:1
    ds_write2_b64 v27, v[40:41], v[42:43] offset0:0 offset1:16
    v_lshlrev_b32 v17, 13, v2
    v_lshrrev_b32 v19, 1, v4
    v_lshlrev_b32 v19, 3, v19
    v_xor_b32 v19, v19, v3
    v_lshlrev_b32 v19, 4, v19
    v_lshl_add_u32 v19, v4, 8, v19
    v_add_u32 v17, v17, v19
    v_and_b32 v18, 1, v0
    v_bfe_u32 v19, v0, 1, 4
    v_lshlrev_b32 v20, 3, v18
    v_xor_b32 v19, v19, v20
    v_lshlrev_b32 v19, 4, v19
    v_lshl_add_u32 v18, v18, 9, v19
    v_lshrrev_b32 v19, 5, v0
    v_lshl_add_u32 v18, v19, 10, v18
    v_mov_b32 v5, v111
    v_add_u32 v8, 8316, v5
    v_add_u32 v9, 4160, v8
    v_mov_b32 v10, 0
    s_cmp_lt_u32 s87, 2
    s_cbranch_scc1 kc_a01
    v_lshlrev_b32 v20, 3, v0
    v_sub_u32 v20, 19448, v20
    s_cmp_eq_u32 s87, 2
    s_cbranch_scc1 kc_a2
    v_lshlrev_b32 v21, 5, v0
    v_sub_u32 v21, 24800, v21
    v_cmp_lt_u32 s[90:91], 31, v1
    v_add_u32 v22, 1792, v20
    v_add_u32 v23, 16, v21
    v_cndmask_b32 v20, v20, v21, s[90:91]
    v_cndmask_b32 v22, v22, v23, s[90:91]
    v_add_u32 v21, 8, v20
    v_add_u32 v23, 8, v22
    v_subrev_u32 v88, 4, v20
    v_cmp_lt_u32 s[88:89], 30, v1
    v_cmp_eq_u32 vcc, 63, v1
    s_memrealtime s[12:13]
    s_waitcnt lgkmcnt(0)
    s_cmp_lg_u32 s21, 0
    s_cbranch_scc1 kc_b0
    s_bfe_u32 s20, s12, 262148
    s_lshl_b32 s20, s20, 11
    s_sub_u32 s12, s12, s54
    s_cmp_lt_u32 s12, 270
    s_cbranch_scc1 kc_b0
    v_lshrrev_b32 v112, 1, v111
    buffer_load_dwordx2 v[112:113], v112, s[8:11], s20 offen
    s_mov_b32 s21, 1
kc_b0:
    s_barrier
    s_cmp_eq_u32 s21, 0
    s_cbranch_scc0 kc_g0
    s_memrealtime s[12:13]
    s_waitcnt lgkmcnt(0)
    s_bfe_u32 s20, s12, 262148
    s_lshl_b32 s20, s20, 11
    s_sub_u32 s12, s12, s54
    s_cmp_lt_u32 s12, 270
    s_cbranch_scc1 kc_f0
    v_lshrrev_b32 v112, 1, v111
    buffer_load_dwordx2 v[112:113], v112, s[8:11], s20 offen
    s_mov_b32 s21, 3
    s_branch kc_f0
kc_g0:
    s_waitcnt vmcnt(0)
    v_sub_co_u32 v112, s[12:13], v112, v108
    s_nop 1
    v_subb_co_u32 v113, s[12:13], v113, v109, s[12:13]
    v_cmp_gt_u64 s[6:7], s[4:5], v[112:113]
    s_cmp_eq_u64 s[6:7], -1
    s_cbranch_scc0 kc_f0
    buffer_load_dwordx4 v[12:15], v126, s[68:71], s23 offen
    buffer_load_dwordx4 v[112:115], v127, s[64:67], 0 offen offset:0
    buffer_load_dwordx4 v[116:119], v127, s[64:67], 0 offen offset:16
    buffer_load_dwordx4 v[120:123], v110, s[76:79], s23 offen
    s_mov_b32 s21, 2
kc_f0:
    ds_read_b128 v[80:83], v10 offset:28928
    ds_read2st64_b64 v[32:35], v20 offset0:0 offset1:6
    ds_read2st64_b64 v[36:39], v20 offset0:12 offset1:18
    ds_read2st64_b64 v[40:43], v21 offset0:0 offset1:6
    ds_read2st64_b64 v[44:47], v21 offset0:12 offset1:18
    ds_read2st64_b64 v[48:51], v22 offset0:0 offset1:6
    ds_read2st64_b64 v[52:55], v22 offset0:12 offset1:18
    ds_read2st64_b64 v[56:59], v23 offset0:0 offset1:6
    ds_read2st64_b64 v[60:63], v23 offset0:12 offset1:18
    ds_read2st64_b32 v[84:85], v88 offset0:0 offset1:12
    ds_read2st64_b32 v[86:87], v88 offset0:24 offset1:36
    s_waitcnt lgkmcnt(10)
    v_max3_f32 v80, v80, v81, v82
    v_max_f32 v80, v80, v83
    v_lshrrev_b32 v82, 23, v80
    v_max_u32 v82, 15, v82
    v_min_u32 v82, 0xfe, v82
    v_sub_u32 v81, 0x104, v82
    v_lshlrev_b32 v81, 23, v81
    s_waitcnt lgkmcnt(8)
    v_add_f32 v32, v32, v34
    v_add_f32 v36, v36, v38
    v_add_f32 v33, v33, v35
    v_add_f32 v37, v37, v39
    v_add_f32 v32, v32, v36
    v_add_f32 v33, v33, v37
    v_mul_f32 v32, v32, v81
    v_mul_f32 v33, v33, v81
    s_waitcnt lgkmcnt(6)
    v_add_f32 v40, v40, v42
    v_add_f32 v44, v44, v46
    v_add_f32 v41, v41, v43
    v_add_f32 v45, v45, v47
    v_add_f32 v40, v40, v44
    v_add_f32 v41, v41, v45
    v_mul_f32 v40, v40, v81
    v_mul_f32 v41, v41, v81
    s_waitcnt lgkmcnt(4)
    v_add_f32 v48, v48, v50
    v_add_f32 v52, v52, v54
    v_add_f32 v49, v49, v51
    v_add_f32 v53, v53, v55
    v_add_f32 v48, v48, v52
    v_add_f32 v49, v49, v53
    v_mul_f32 v48, v48, v81
    v_mul_f32 v49, v49, v81
    s_waitcnt lgkmcnt(2)
    v_add_f32 v56, v56, v58
    v_add_f32 v60, v60, v62
    v_add_f32 v57, v57, v59
    v_add_f32 v61, v61, v63
    v_add_f32 v56, v56, v60
    v_add_f32 v57, v57, v61
    v_mul_f32 v56, v56, v81
    v_mul_f32 v57, v57, v81
    v_cndmask_b32 v72, v40, v57, s[90:91]
    v_cndmask_b32 v73, v49, v56, s[90:91]
    v_cndmask_b32 v74, v33, v49, s[90:91]
    v_cndmask_b32 v75, v33, v48, s[90:91]
    v_cndmask_b32 v76, v33, v41, s[90:91]
    v_cndmask_b32 v77, v48, v40, s[90:91]
    v_cndmask_b32 v78, v32, v33, s[90:91]
    v_cvt_pk_f16_f32 v64, v72, v73
    v_cvt_pk_f16_f32 v65, v74, v75
    v_cvt_pk_f16_f32 v66, v76, v77
    v_cvt_pk_f16_f32 v67, v78, v32
    s_waitcnt lgkmcnt(0)
    v_add_f32 v84, v84, v85
    v_add_f32 v86, v86, v87
    v_add_f32 v84, v84, v86
    v_mul_f32 v84, v84, v81
    v_cndmask_b32 v84, v32, v84, s[88:89]
    v_cndmask_b32 v84, v84, v10, vcc
    v_cvt_pk_f16_f32 v68, v73, v74
    v_cvt_pk_f16_f32 v69, v75, v76
    v_cvt_pk_f16_f32 v70, v77, v78
    v_cvt_pk_f16_f32 v71, v32, v84
    s_branch kc_st
kc_a2:
    v_add_u32 v21, 8, v20
    s_memrealtime s[12:13]
    s_waitcnt lgkmcnt(0)
    s_cmp_lg_u32 s21, 0
    s_cbranch_scc1 kc_b1
    s_bfe_u32 s20, s12, 262148
    s_lshl_b32 s20, s20, 11
    s_sub_u32 s12, s12, s54
    s_cmp_lt_u32 s12, 270
    s_cbranch_scc1 kc_b1
    v_lshrrev_b32 v112, 1, v111
    buffer_load_dwordx2 v[112:113], v112, s[8:11], s20 offen
    s_mov_b32 s21, 1
kc_b1:
    s_barrier
    s_cmp_eq_u32 s21, 0
    s_cbranch_scc0 kc_g1
    s_memrealtime s[12:13]
    s_waitcnt lgkmcnt(0)
    s_bfe_u32 s20, s12, 262148
    s_lshl_b32 s20, s20, 11
    s_sub_u32 s12, s12, s54
    s_cmp_lt_u32 s12, 270
    s_cbranch_scc1 kc_f1
    v_lshrrev_b32 v112, 1, v111
    buffer_load_dwordx2 v[112:113], v112, s[8:11], s20 offen
    s_mov_b32 s21, 3
    s_branch kc_f1
kc_g1:
    s_waitcnt vmcnt(0)
    v_sub_co_u32 v112, s[12:13], v112, v108
    s_nop 1
    v_subb_co_u32 v113, s[12:13], v113, v109, s[12:13]
    v_cmp_gt_u64 s[6:7], s[4:5], v[112:113]
    s_cmp_eq_u64 s[6:7], -1
    s_cbranch_scc0 kc_f1
    buffer_load_dwordx4 v[12:15], v126, s[68:71], s23 offen
    buffer_load_dwordx4 v[112:115], v127, s[64:67], 0 offen offset:0
    buffer_load_dwordx4 v[116:119], v127, s[64:67], 0 offen offset:16
    buffer_load_dwordx4 v[120:123], v110, s[76:79], s23 offen
    s_mov_b32 s21, 2
kc_f1:
    ds_read_b128 v[80:83], v10 offset:28928
    ds_read2st64_b64 v[32:35], v20 offset0:0 offset1:6
    ds_read2st64_b64 v[36:39], v20 offset0:12 offset1:18
    ds_read2st64_b32 v[40:41], v21 offset0:0 offset1:12
    ds_read2st64_b32 v[42:43], v21 offset0:24 offset1:36
    s_waitcnt lgkmcnt(4)
    v_max3_f32 v80, v80, v81, v82
    v_max_f32 v80, v80, v83
    v_lshrrev_b32 v82, 23, v80
    v_max_u32 v82, 15, v82
    v_min_u32 v82, 0xfe, v82
    v_sub_u32 v81, 0x104, v82
    v_lshlrev_b32 v81, 23, v81
    s_waitcnt lgkmcnt(0)
    v_add_f32 v32, v32, v34
    v_add_f32 v36, v36, v38
    v_add_f32 v40, v40, v41
    v_add_f32 v33, v33, v35
    v_add_f32 v37, v37, v39
    v_add_f32 v42, v42, v43
    v_add_f32 v32, v32, v36
    v_add_f32 v33, v33, v37
    v_add_f32 v34, v40, v42
    v_mul_f32 v32, v32, v81
    v_mul_f32 v33, v33, v81
    v_mul_f32 v34, v34, v81
    v_cvt_pk_f16_f32 v64, v34, v34
    v_cvt_pk_f16_f32 v65, v33, v33
    v_cvt_pk_f16_f32 v66, v33, v32
    v_cvt_pk_f16_f32 v67, v32, v32
    v_cvt_pk_f16_f32 v68, v34, v33
    v_mov_b32 v69, v65
    v_mov_b32 v70, v67
    v_mov_b32 v71, v67
    s_branch kc_st
kc_a01:
    v_lshlrev_b32 v20, 2, v0
    v_sub_u32 v20, 18940, v20
    v_add_u32 v21, 4, v20
    v_and_b32 v22, 1, v0
    v_cmp_eq_u32 s[90:91], 0, v22
    s_memrealtime s[12:13]
    s_waitcnt lgkmcnt(0)
    s_cmp_lg_u32 s21, 0
    s_cbranch_scc1 kc_b2
    s_bfe_u32 s20, s12, 262148
    s_lshl_b32 s20, s20, 11
    s_sub_u32 s12, s12, s54
    s_cmp_lt_u32 s12, 270
    s_cbranch_scc1 kc_b2
    v_lshrrev_b32 v112, 1, v111
    buffer_load_dwordx2 v[112:113], v112, s[8:11], s20 offen
    s_mov_b32 s21, 1
kc_b2:
    s_barrier
    s_cmp_eq_u32 s21, 0
    s_cbranch_scc0 kc_g2
    s_memrealtime s[12:13]
    s_waitcnt lgkmcnt(0)
    s_bfe_u32 s20, s12, 262148
    s_lshl_b32 s20, s20, 11
    s_sub_u32 s12, s12, s54
    s_cmp_lt_u32 s12, 270
    s_cbranch_scc1 kc_f2
    v_lshrrev_b32 v112, 1, v111
    buffer_load_dwordx2 v[112:113], v112, s[8:11], s20 offen
    s_mov_b32 s21, 3
    s_branch kc_f2
kc_g2:
    s_waitcnt vmcnt(0)
    v_sub_co_u32 v112, s[12:13], v112, v108
    s_nop 1
    v_subb_co_u32 v113, s[12:13], v113, v109, s[12:13]
    v_cmp_gt_u64 s[6:7], s[4:5], v[112:113]
    s_cmp_eq_u64 s[6:7], -1
    s_cbranch_scc0 kc_f2
    buffer_load_dwordx4 v[12:15], v126, s[68:71], s23 offen
    buffer_load_dwordx4 v[112:115], v127, s[64:67], 0 offen offset:0
    buffer_load_dwordx4 v[116:119], v127, s[64:67], 0 offen offset:16
    buffer_load_dwordx4 v[120:123], v110, s[76:79], s23 offen
    s_mov_b32 s21, 2
kc_f2:
    ds_read_b128 v[80:83], v10 offset:28928
    ds_read2st64_b32 v[32:33], v20 offset0:0 offset1:12
    ds_read2st64_b32 v[34:35], v20 offset0:24 offset1:36
    ds_read2st64_b32 v[36:37], v21 offset0:0 offset1:12
    ds_read2st64_b32 v[38:39], v21 offset0:24 offset1:36
    v_mov_b32 v28, 0
    v_mov_b32 v29, 0
    v_mov_b32 v30, 0
    v_mov_b32 v31, 0
    v_lshrrev_b32 v19, 1, v0
    v_mul_u32_u24 v19, 4128, v19
    v_add_u32 v19, v19, v5
    v_cmp_gt_u32 vcc, 30, v0
    s_and_saveexec_b64 s[32:33], vcc
    s_cbranch_execz kc_nopad
    ds_write_b128 v5, v[28:31] offset:32768
    v_cmp_gt_u32 vcc, 8, v0
    s_and_b64 exec, exec, vcc
    ds_write_b128 v19, v[28:31] offset:4096
    s_mov_b64 exec, 1
    ds_write_b32 v10, v10 offset:12412
    ds_write_b32 v10, v10 offset:16572
kc_nopad:
    s_mov_b64 exec, s[32:33]
    s_waitcnt lgkmcnt(0)
    v_max3_f32 v80, v80, v81, v82
    v_max_f32 v80, v80, v83
    v_lshrrev_b32 v82, 23, v80
    v_max_u32 v82, 15, v82
    v_min_u32 v82, 0xfe, v82
    v_sub_u32 v81, 0x104, v82
    v_lshlrev_b32 v81, 23, v81
    s_waitcnt lgkmcnt(0)
    v_add_f32 v32, v32, v33
    v_add_f32 v34, v34, v35
    v_add_f32 v36, v36, v37
    v_add_f32 v38, v38, v39
    v_add_f32 v32, v32, v34
    v_add_f32 v36, v36, v38
    v_mul_f32 v32, v32, v81
    v_mul_f32 v36, v36, v81
    v_cndmask_b32 v33, v32, v36, s[90:91]
    v_cvt_pk_f16_f32 v64, v36, v36
    v_cvt_pk_f16_f32 v65, v36, v33
    v_cvt_pk_f16_f32 v66, v32, v32
    v_mov_b32 v67, v66
    v_mov_b32 v68, v64
    v_cvt_pk_f16_f32 v69, v33, v32
    v_mov_b32 v70, v66
    v_mov_b32 v71, v66
kc_st:
    v_subrev_u32 v82, 6, v82
    v_lshlrev_b32 v82, 23, v82
    v_mul_f32 v82, v82, v7
    ds_write_b128 v5, v[64:67] offset:0
    ds_write_b128 v5, v[68:71] offset:4160
    ds_write2_b32 v8, v64, v65 offset0:0 offset1:1
    ds_write2_b32 v8, v66, v67 offset0:2 offset1:3
    ds_write2_b32 v9, v68, v69 offset0:0 offset1:1
    ds_write2_b32 v9, v70, v71 offset0:2 offset1:3
    v_mov_b32 v124, v82
    s_setprio 0
    s_mov_b32 s34, 0xffff0000
    s_and_b32 s45, s86, 1
    s_lshl_b32 s46, s58, 16
    s_and_b32 s44, s58, 0xffff0000
    s_cmp_eq_u32 s45, 1
    s_cselect_b32 s44, s44, s46
    s_mov_b32 s46, 0x42000000
    s_cmp_eq_u32 s21, 2
    s_cbranch_scc1 kc_have
    s_mov_b32 s59, 0
    s_cmp_eq_u32 s21, 1
    s_cbranch_scc1 kc_loop
    s_cmp_eq_u32 s21, 3
    s_cbranch_scc1 kc_t
    s_mov_b32 s14, 0
kc_gate:
    s_memrealtime s[12:13]
    s_add_u32 s14, s14, 1
    s_waitcnt lgkmcnt(0)
    s_sub_u32 s12, s12, s54
    s_cmp_ge_u32 s12, 270
    s_cbranch_scc1 kc_gate_e
    s_sleep 4
    s_cmp_lt_u32 s14, 256
    s_cbranch_scc1 kc_gate
kc_gate_e:
    s_add_u32 s12, s12, s54
    s_bfe_u32 s20, s12, 262148
    s_lshl_b32 s20, s20, 11
    v_lshrrev_b32 v112, 1, v111
    buffer_load_dwordx2 v[112:113], v112, s[8:11], s20 offen
    s_branch kc_t
kc_loop:
    s_memrealtime s[12:13]
    s_waitcnt lgkmcnt(0)
    s_bfe_u32 s20, s12, 262148
    s_lshl_b32 s20, s20, 11
    s_sub_u32 s12, s12, s54
    s_cmp_ge_u32 s12, 466
    s_cbranch_scc1 kc_sc
    v_lshrrev_b32 v112, 1, v111
    buffer_load_dwordx2 v[112:113], v112, s[8:11], s20 offen
    s_mov_b32 s59, 1
    s_branch kc_t
kc_sc:
    s_and_b32 s6, s59, 3
    s_cmp_eq_u32 s6, 3
    s_cbranch_scc1 kc_t0
    v_lshrrev_b32 v112, 1, v111
    buffer_load_dwordx2 v[112:113], v112, s[8:11], s20 offen sc1
    s_branch kc_t
kc_t0:
    buffer_load_dwordx2 v[56:57], off, s[80:83], 0 offset:32 sc1
    v_lshrrev_b32 v112, 1, v111
    buffer_load_dwordx2 v[112:113], v112, s[8:11], s20 offen sc1
    s_waitcnt vmcnt(1)
    v_not_b32 v56, v56
    v_not_b32 v57, v57
    v_cmp_lt_u64 vcc, v[56:57], v[108:109]
    s_nop 1
    v_cndmask_b32 v108, v108, v56, vcc
    v_cndmask_b32 v109, v109, v57, vcc
kc_t:
    s_waitcnt vmcnt(0)
    v_sub_co_u32 v112, vcc, v112, v108
    v_subb_co_u32 v113, vcc, v113, v109, vcc
    v_cmp_gt_u64 s[6:7], s[4:5], v[112:113]
    s_cmp_eq_u64 s[6:7], -1
    s_cbranch_scc1 kc_ok
    s_add_u32 s59, s59, 1
    s_cmp_eq_u32 s59, 1
    s_cbranch_scc1 kc_loop
    s_sleep 16
    s_and_b32 s6, s59, 15
    s_cbranch_scc1 kc_next
    s_mov_b64 exec, 15
    v_lshlrev_b32 v112, 6, v1
    buffer_load_dword v112, v112, s[80:83], 0 offen sc1
    s_waitcnt vmcnt(0)
    v_cmp_eq_u32 vcc, 64, v112
    s_mov_b64 exec, -1
    s_cmp_eq_u32 vcc_lo, 15
    s_cbranch_scc1 kc_ok
kc_next:
    s_cmp_lt_u32 s59, 32768
    s_cbranch_scc1 kc_loop
kc_ok:
    buffer_load_dwordx4 v[12:15], v126, s[68:71], s23 offen
    buffer_load_dwordx4 v[112:115], v127, s[64:67], 0 offen offset:0
    buffer_load_dwordx4 v[116:119], v127, s[64:67], 0 offen offset:16
    buffer_load_dwordx4 v[120:123], v110, s[76:79], s23 offen
kc_have:
    s_waitcnt vmcnt(1)
    v_and_b32 v48, s34, v112
    v_and_b32 v49, s34, v113
    v_and_b32 v50, s34, v114
    v_and_b32 v51, s34, v115
    v_and_b32 v52, s34, v116
    v_and_b32 v53, s34, v117
    v_and_b32 v54, s34, v118
    v_and_b32 v55, s34, v119
    v_rcp_f32 v48, v48
    v_lshlrev_b32 v112, 16, v112
    v_rcp_f32 v49, v49
    v_lshlrev_b32 v113, 16, v113
    v_rcp_f32 v50, v50
    v_lshlrev_b32 v114, 16, v114
    v_rcp_f32 v51, v51
    v_lshlrev_b32 v115, 16, v115
    v_rcp_f32 v52, v52
    v_lshlrev_b32 v116, 16, v116
    v_rcp_f32 v53, v53
    v_lshlrev_b32 v117, 16, v117
    v_rcp_f32 v54, v54
    v_lshlrev_b32 v118, 16, v118
    v_rcp_f32 v55, v55
    v_lshlrev_b32 v119, 16, v119
    v_lshlrev_b32 v40, 16, v12
    v_and_b32 v41, s34, v12
    v_sub_f32 v40, v40, v112
    v_sub_f32 v41, v41, v113
    v_cvt_pk_bf16_f32 v40, v40, v41
    v_and_b32 v41, s34, v40
    v_lshlrev_b32 v40, 16, v40
    v_mul_f32 v40, v40, v48
    v_mul_f32 v41, v41, v49
    v_cvt_pk_bf16_f32 v40, v40, v41
    v_and_b32 v41, s34, v40
    v_lshlrev_b32 v40, 16, v40
    v_lshlrev_b32 v42, 16, v13
    v_and_b32 v43, s34, v13
    v_sub_f32 v42, v42, v114
    v_sub_f32 v43, v43, v115
    v_cvt_pk_bf16_f32 v42, v42, v43
    v_and_b32 v43, s34, v42
    v_lshlrev_b32 v42, 16, v42
    v_mul_f32 v42, v42, v50
    v_mul_f32 v43, v43, v51
    v_cvt_pk_bf16_f32 v42, v42, v43
    v_and_b32 v43, s34, v42
    v_lshlrev_b32 v42, 16, v42
    v_lshlrev_b32 v44, 16, v14
    v_and_b32 v45, s34, v14
    v_sub_f32 v44, v44, v116
    v_sub_f32 v45, v45, v117
    v_cvt_pk_bf16_f32 v44, v44, v45
    v_and_b32 v45, s34, v44
    v_lshlrev_b32 v44, 16, v44
    v_mul_f32 v44, v44, v52
    v_mul_f32 v45, v45, v53
    v_cvt_pk_bf16_f32 v44, v44, v45
    v_and_b32 v45, s34, v44
    v_lshlrev_b32 v44, 16, v44
    v_lshlrev_b32 v46, 16, v15
    v_and_b32 v47, s34, v15
    v_sub_f32 v46, v46, v118
    v_sub_f32 v47, v47, v119
    v_cvt_pk_bf16_f32 v46, v46, v47
    v_and_b32 v47, s34, v46
    v_lshlrev_b32 v46, 16, v46
    v_mul_f32 v46, v46, v54
    v_mul_f32 v47, v47, v55
    v_cvt_pk_bf16_f32 v46, v46, v47
    v_and_b32 v47, s34, v46
    v_lshlrev_b32 v46, 16, v46
    s_waitcnt vmcnt(0)
    v_sub_co_u32 v120, vcc, v120, v108
    v_subb_co_u32 v121, vcc, v121, v109, vcc
    v_cmp_gt_u64 s[6:7], s[4:5], v[120:121]
    s_cmp_eq_u64 s[6:7], -1
    s_cbranch_scc1 kq_ok
    s_mov_b32 s12, 0
kq_loop:
    s_and_b32 s14, s12, 3
    s_cmp_eq_u32 s14, 3
    s_cbranch_scc1 kq_t0
    buffer_load_dwordx4 v[120:123], v110, s[76:79], s23 offen sc1
    s_branch kq_t
kq_t0:
    buffer_load_dwordx2 v[56:57], off, s[80:83], 0 offset:32 sc1
    buffer_load_dwordx4 v[120:123], v110, s[76:79], s23 offen sc1
    s_waitcnt vmcnt(1)
    v_not_b32 v56, v56
    v_not_b32 v57, v57
    v_cmp_lt_u64 vcc, v[56:57], v[108:109]
    s_nop 1
    v_cndmask_b32 v108, v108, v56, vcc
    v_cndmask_b32 v109, v109, v57, vcc
kq_t:
    s_waitcnt vmcnt(0)
    v_sub_co_u32 v120, vcc, v120, v108
    v_subb_co_u32 v121, vcc, v121, v109, vcc
    v_cmp_gt_u64 s[14:15], s[4:5], v[120:121]
    s_cmp_eq_u64 s[14:15], -1
    s_cbranch_scc1 kq_ok
    s_add_u32 s12, s12, 1
    s_cmp_eq_u32 s12, 1
    s_cbranch_scc1 kq_loop
    s_sleep 16
    s_and_b32 s14, s12, 15
    s_cbranch_scc1 kq_next
    s_mov_b64 exec, 15
    v_lshlrev_b32 v120, 6, v1
    buffer_load_dword v120, v120, s[80:83], 0 offen sc1
    s_waitcnt vmcnt(0)
    v_cmp_eq_u32 vcc, 64, v120
    s_mov_b64 exec, -1
    s_cmp_eq_u32 vcc_lo, 15
    s_cbranch_scc0 kq_next
    buffer_load_dwordx4 v[120:123], v110, s[76:79], s23 offen sc1
    s_waitcnt vmcnt(0)
    s_branch kq_ok
kq_next:
    s_cmp_lt_u32 s12, 32768
    s_cbranch_scc1 kq_loop
kq_ok:
    s_nop 1
    v_add_f32_dpp v122, v122, v122 quad_perm:[1,0,3,2] row_mask:0xf bank_mask:0xf
    s_nop 1
    v_add_f32_dpp v122, v122, v122 quad_perm:[2,3,0,1] row_mask:0xf bank_mask:0xf
    v_cvt_pk_bf16_f32 v122, v122, v122
    v_lshlrev_b32 v122, 16, v122
    s_nop 0
    v_readlane_b32 s40, v122, 0
    v_readlane_b32 s41, v122, 4
    v_readlane_b32 s42, v122, 8
    s_nop 0
    v_mov_b32 v19, s41
    v_add_f32 v19, 1.0, v19
    v_cvt_pk_bf16_f32 v19, v19, v19
    v_lshlrev_b32 v19, 16, v19
    v_mov_b32 v20, s40
    v_mul_f32 v21, s46, |v19|
    v_add_f32 v21, v21, |v20|
    v_lshrrev_b32 v7, 23, v21
    v_max_u32 v7, 15, v7
    v_min_u32 v7, 0xfe, v7
    v_sub_u32 v22, 0x10c, v7
    v_lshlrev_b32 v22, 23, v22
    v_subrev_u32 v7, 14, v7
    v_lshlrev_b32 v7, 23, v7
    v_mul_f32 v7, v124, v7
    v_mul_f32 v40, v40, v19
    v_mul_f32 v41, v41, v19
    v_cvt_pk_bf16_f32 v40, v40, v41
    v_and_b32 v41, s34, v40
    v_lshlrev_b32 v40, 16, v40
    v_add_f32 v40, s40, v40
    v_add_f32 v41, s40, v41
    v_cvt_pk_bf16_f32 v8, v40, v41
    v_lshlrev_b32 v40, 16, v8
    v_and_b32 v41, s34, v8
    v_mul_f32 v40, v40, v22
    v_mul_f32 v41, v41, v22
    v_cvt_pkrtz_f16_f32 v24, v40, v41
    v_mul_f32 v42, v42, v19
    v_mul_f32 v43, v43, v19
    v_cvt_pk_bf16_f32 v42, v42, v43
    v_and_b32 v43, s34, v42
    v_lshlrev_b32 v42, 16, v42
    v_add_f32 v42, s40, v42
    v_add_f32 v43, s40, v43
    v_cvt_pk_bf16_f32 v9, v42, v43
    v_lshlrev_b32 v42, 16, v9
    v_and_b32 v43, s34, v9
    v_mul_f32 v42, v42, v22
    v_mul_f32 v43, v43, v22
    v_cvt_pkrtz_f16_f32 v25, v42, v43
    v_mul_f32 v44, v44, v19
    v_mul_f32 v45, v45, v19
    v_cvt_pk_bf16_f32 v44, v44, v45
    v_and_b32 v45, s34, v44
    v_lshlrev_b32 v44, 16, v44
    v_add_f32 v44, s40, v44
    v_add_f32 v45, s40, v45
    v_cvt_pk_bf16_f32 v10, v44, v45
    v_lshlrev_b32 v44, 16, v10
    v_and_b32 v45, s34, v10
    v_mul_f32 v44, v44, v22
    v_mul_f32 v45, v45, v22
    v_cvt_pkrtz_f16_f32 v26, v44, v45
    v_mul_f32 v46, v46, v19
    v_mul_f32 v47, v47, v19
    v_cvt_pk_bf16_f32 v46, v46, v47
    v_and_b32 v47, s34, v46
    v_lshlrev_b32 v46, 16, v46
    v_add_f32 v46, s40, v46
    v_add_f32 v47, s40, v47
    v_cvt_pk_bf16_f32 v11, v46, v47
    v_lshlrev_b32 v46, 16, v11
    v_and_b32 v47, s34, v11
    v_mul_f32 v46, v46, v22
    v_mul_f32 v47, v47, v22
    v_cvt_pkrtz_f16_f32 v27, v46, v47
    ds_write_b128 v5, v[24:27] offset:33248
    s_waitcnt lgkmcnt(0)
    s_barrier
    ds_read_b128 v[20:23], v16 offset:32768
    ds_read_b64 v[64:65], v6 offset:3584
    ds_read_b64 v[66:67], v6 offset:3592
    ds_read_b64 v[72:73], v6 offset:3072
    ds_read_b64 v[74:75], v6 offset:3080
    ds_read_b64 v[80:81], v6 offset:2560
    ds_read_b64 v[82:83], v6 offset:2568
    ds_read_b64 v[88:89], v6 offset:2048
    ds_read_b64 v[90:91], v6 offset:2056
    ds_read_b64 v[96:97], v6 offset:1536
    ds_read_b64 v[98:99], v6 offset:1544
    s_waitcnt lgkmcnt(8)
    v_mfma_f32_16x16x32_f16 v[28:31], v[64:67], v[20:23], 0
    ds_read_b64 v[104:105], v6 offset:1024
    ds_read_b64 v[106:107], v6 offset:1032
    ds_read_b64 v[112:113], v6 offset:512
    ds_read_b64 v[114:115], v6 offset:520
    s_waitcnt lgkmcnt(10)
    v_mfma_f32_16x16x32_f16 v[32:35], v[72:75], v[20:23], 0
    ds_read_b64 v[120:121], v6 offset:0
    ds_read_b64 v[122:123], v6 offset:8
    ds_read_b128 v[24:27], v16 offset:33024
    s_waitcnt lgkmcnt(11)
    v_mfma_f32_16x16x32_f16 v[36:39], v[80:83], v[20:23], 0
    ds_read_b64 v[60:61], v6 offset:3840
    ds_read_b64 v[62:63], v6 offset:3848
    ds_read_b64 v[68:69], v6 offset:3328
    ds_read_b64 v[70:71], v6 offset:3336
    s_waitcnt lgkmcnt(13)
    v_mfma_f32_16x16x32_f16 v[40:43], v[88:91], v[20:23], 0
    ds_read_b64 v[76:77], v6 offset:2816
    ds_read_b64 v[78:79], v6 offset:2824
    ds_read_b64 v[84:85], v6 offset:2304
    ds_read_b64 v[86:87], v6 offset:2312
    s_waitcnt lgkmcnt(15)
    v_mfma_f32_16x16x32_f16 v[44:47], v[96:99], v[20:23], 0
    ds_read_b64 v[92:93], v6 offset:1792
    ds_read_b64 v[94:95], v6 offset:1800
    ds_read_b64 v[100:101], v6 offset:1280
    ds_read_b64 v[102:103], v6 offset:1288
    s_waitcnt lgkmcnt(15)
    v_mfma_f32_16x16x32_f16 v[48:51], v[104:107], v[20:23], 0
    ds_read_b64 v[108:109], v6 offset:768
    ds_read_b64 v[110:111], v6 offset:776
    ds_read_b64 v[116:117], v6 offset:256
    ds_read_b64 v[118:119], v6 offset:264
    v_mfma_f32_16x16x32_f16 v[52:55], v[112:115], v[20:23], 0
    s_waitcnt lgkmcnt(15)
    v_mfma_f32_16x16x32_f16 v[56:59], v[120:123], v[20:23], 0
    ds_read_b128 v[20:23], v16 offset:33280
    s_waitcnt lgkmcnt(15)
    v_mfma_f32_16x16x32_f16 v[28:31], v[60:63], v[24:27], v[28:31]
    s_waitcnt lgkmcnt(13)
    v_mfma_f32_16x16x32_f16 v[32:35], v[68:71], v[24:27], v[32:35]
    s_waitcnt lgkmcnt(11)
    v_mfma_f32_16x16x32_f16 v[36:39], v[76:79], v[24:27], v[36:39]
    s_waitcnt lgkmcnt(9)
    v_mfma_f32_16x16x32_f16 v[40:43], v[84:87], v[24:27], v[40:43]
    s_waitcnt lgkmcnt(7)
    v_mfma_f32_16x16x32_f16 v[44:47], v[92:95], v[24:27], v[44:47]
    s_waitcnt lgkmcnt(5)
    v_mfma_f32_16x16x32_f16 v[48:51], v[100:103], v[24:27], v[48:51]
    s_waitcnt lgkmcnt(3)
    v_mfma_f32_16x16x32_f16 v[52:55], v[108:111], v[24:27], v[52:55]
    s_waitcnt lgkmcnt(1)
    v_mfma_f32_16x16x32_f16 v[56:59], v[116:119], v[24:27], v[56:59]
    ds_read_b128 v[24:27], v16 offset:33536
    s_barrier
    s_waitcnt lgkmcnt(1)
    v_mfma_f32_16x16x32_f16 v[32:35], v[64:67], v[20:23], v[32:35]
    v_mfma_f32_16x16x32_f16 v[36:39], v[72:75], v[20:23], v[36:39]
    v_mfma_f32_16x16x32_f16 v[40:43], v[80:83], v[20:23], v[40:43]
    v_mfma_f32_16x16x32_f16 v[44:47], v[88:91], v[20:23], v[44:47]
    v_mfma_f32_16x16x32_f16 v[48:51], v[96:99], v[20:23], v[48:51]
    v_mfma_f32_16x16x32_f16 v[52:55], v[104:107], v[20:23], v[52:55]
    v_mfma_f32_16x16x32_f16 v[56:59], v[112:115], v[20:23], v[56:59]
    ds_read_b128 v[20:23], v16 offset:33792
    s_waitcnt lgkmcnt(1)
    v_mfma_f32_16x16x32_f16 v[32:35], v[60:63], v[24:27], v[32:35]
    v_mfma_f32_16x16x32_f16 v[36:39], v[68:71], v[24:27], v[36:39]
    v_mfma_f32_16x16x32_f16 v[40:43], v[76:79], v[24:27], v[40:43]
    v_mfma_f32_16x16x32_f16 v[44:47], v[84:87], v[24:27], v[44:47]
    v_mfma_f32_16x16x32_f16 v[48:51], v[92:95], v[24:27], v[48:51]
    v_mfma_f32_16x16x32_f16 v[52:55], v[100:103], v[24:27], v[52:55]
    v_mfma_f32_16x16x32_f16 v[56:59], v[108:111], v[24:27], v[56:59]
    ds_read_b128 v[24:27], v16 offset:34048
    s_waitcnt lgkmcnt(1)
    v_mfma_f32_16x16x32_f16 v[36:39], v[64:67], v[20:23], v[36:39]
    v_mfma_f32_16x16x32_f16 v[40:43], v[72:75], v[20:23], v[40:43]
    v_mfma_f32_16x16x32_f16 v[44:47], v[80:83], v[20:23], v[44:47]
    v_mfma_f32_16x16x32_f16 v[48:51], v[88:91], v[20:23], v[48:51]
    v_mfma_f32_16x16x32_f16 v[52:55], v[96:99], v[20:23], v[52:55]
    v_mfma_f32_16x16x32_f16 v[56:59], v[104:107], v[20:23], v[56:59]
    ds_read_b128 v[20:23], v16 offset:34304
    s_waitcnt lgkmcnt(1)
    v_mfma_f32_16x16x32_f16 v[36:39], v[60:63], v[24:27], v[36:39]
    v_mfma_f32_16x16x32_f16 v[40:43], v[68:71], v[24:27], v[40:43]
    v_mfma_f32_16x16x32_f16 v[44:47], v[76:79], v[24:27], v[44:47]
    v_mfma_f32_16x16x32_f16 v[48:51], v[84:87], v[24:27], v[48:51]
    v_mfma_f32_16x16x32_f16 v[52:55], v[92:95], v[24:27], v[52:55]
    v_mfma_f32_16x16x32_f16 v[56:59], v[100:103], v[24:27], v[56:59]
    ds_read_b128 v[24:27], v16 offset:34560
    s_waitcnt lgkmcnt(1)
    v_mfma_f32_16x16x32_f16 v[40:43], v[64:67], v[20:23], v[40:43]
    v_mfma_f32_16x16x32_f16 v[44:47], v[72:75], v[20:23], v[44:47]
    v_mfma_f32_16x16x32_f16 v[48:51], v[80:83], v[20:23], v[48:51]
    v_mfma_f32_16x16x32_f16 v[52:55], v[88:91], v[20:23], v[52:55]
    v_mfma_f32_16x16x32_f16 v[56:59], v[96:99], v[20:23], v[56:59]
    ds_read_b128 v[20:23], v16 offset:34816
    s_waitcnt lgkmcnt(1)
    v_mfma_f32_16x16x32_f16 v[40:43], v[60:63], v[24:27], v[40:43]
    v_mfma_f32_16x16x32_f16 v[44:47], v[68:71], v[24:27], v[44:47]
    v_mfma_f32_16x16x32_f16 v[48:51], v[76:79], v[24:27], v[48:51]
    v_mfma_f32_16x16x32_f16 v[52:55], v[84:87], v[24:27], v[52:55]
    v_mfma_f32_16x16x32_f16 v[56:59], v[92:95], v[24:27], v[56:59]
    ds_read_b128 v[24:27], v16 offset:35072
    s_waitcnt lgkmcnt(1)
    v_mfma_f32_16x16x32_f16 v[44:47], v[64:67], v[20:23], v[44:47]
    v_mfma_f32_16x16x32_f16 v[48:51], v[72:75], v[20:23], v[48:51]
    v_mfma_f32_16x16x32_f16 v[52:55], v[80:83], v[20:23], v[52:55]
    v_mfma_f32_16x16x32_f16 v[56:59], v[88:91], v[20:23], v[56:59]
    ds_read_b128 v[20:23], v16 offset:35328
    s_waitcnt lgkmcnt(1)
    v_mfma_f32_16x16x32_f16 v[44:47], v[60:63], v[24:27], v[44:47]
    v_mfma_f32_16x16x32_f16 v[48:51], v[68:71], v[24:27], v[48:51]
    v_mfma_f32_16x16x32_f16 v[52:55], v[76:79], v[24:27], v[52:55]
    v_mfma_f32_16x16x32_f16 v[56:59], v[84:87], v[24:27], v[56:59]
    ds_read_b128 v[24:27], v16 offset:35584
    s_waitcnt lgkmcnt(1)
    v_mfma_f32_16x16x32_f16 v[48:51], v[64:67], v[20:23], v[48:51]
    v_mfma_f32_16x16x32_f16 v[52:55], v[72:75], v[20:23], v[52:55]
    v_mfma_f32_16x16x32_f16 v[56:59], v[80:83], v[20:23], v[56:59]
    ds_read_b128 v[20:23], v16 offset:35840
    s_waitcnt lgkmcnt(1)
    v_mfma_f32_16x16x32_f16 v[48:51], v[60:63], v[24:27], v[48:51]
    v_mfma_f32_16x16x32_f16 v[52:55], v[68:71], v[24:27], v[52:55]
    v_mfma_f32_16x16x32_f16 v[56:59], v[76:79], v[24:27], v[56:59]
    ds_read_b128 v[24:27], v16 offset:36096
    s_waitcnt lgkmcnt(1)
    v_mfma_f32_16x16x32_f16 v[52:55], v[64:67], v[20:23], v[52:55]
    v_mfma_f32_16x16x32_f16 v[56:59], v[72:75], v[20:23], v[56:59]
    ds_read_b128 v[20:23], v16 offset:36352
    s_waitcnt lgkmcnt(1)
    v_mfma_f32_16x16x32_f16 v[52:55], v[60:63], v[24:27], v[52:55]
    v_mfma_f32_16x16x32_f16 v[56:59], v[68:71], v[24:27], v[56:59]
    ds_read_b128 v[24:27], v16 offset:36608
    s_waitcnt lgkmcnt(1)
    v_mfma_f32_16x16x32_f16 v[56:59], v[64:67], v[20:23], v[56:59]
    s_waitcnt lgkmcnt(0)
    v_mfma_f32_16x16x32_f16 v[56:59], v[60:63], v[24:27], v[56:59]
    s_nop 7
    ds_write_b128 v17, v[28:31] offset:0
    ds_write_b128 v17, v[32:35] offset:1024
    ds_write_b128 v17, v[36:39] offset:2048
    ds_write_b128 v17, v[40:43] offset:3072
    ds_write_b128 v17, v[44:47] offset:4096
    ds_write_b128 v17, v[48:51] offset:5120
    s_nop 7
    ds_write_b128 v17, v[52:55] offset:6144
    ds_write_b128 v17, v[56:59] offset:7168
    s_waitcnt lgkmcnt(0)
    s_barrier
    ds_read_b128 v[28:31], v18 offset:0
    ds_read_b128 v[32:35], v18 offset:256
    ds_read_b128 v[36:39], v18 offset:8192
    ds_read_b128 v[40:43], v18 offset:8448
    ds_read_b128 v[44:47], v18 offset:16384
    ds_read_b128 v[48:51], v18 offset:16640
    ds_read_b128 v[52:55], v18 offset:24576
    ds_read_b128 v[56:59], v18 offset:24832
    v_lshlrev_b32 v20, 16, v8
    v_and_b32 v21, s34, v8
    v_mul_f32 v20, s44, v20
    v_mul_f32 v21, s44, v21
    v_cvt_pk_bf16_f32 v8, v20, v21
    v_lshlrev_b32 v20, 16, v9
    v_and_b32 v21, s34, v9
    v_mul_f32 v20, s44, v20
    v_mul_f32 v21, s44, v21
    v_cvt_pk_bf16_f32 v9, v20, v21
    v_lshlrev_b32 v20, 16, v10
    v_and_b32 v21, s34, v10
    v_mul_f32 v20, s44, v20
    v_mul_f32 v21, s44, v21
    v_cvt_pk_bf16_f32 v10, v20, v21
    v_lshlrev_b32 v20, 16, v11
    v_and_b32 v21, s34, v11
    v_mul_f32 v20, s44, v20
    v_mul_f32 v21, s44, v21
    v_cvt_pk_bf16_f32 v11, v20, v21
    s_waitcnt lgkmcnt(0)
    v_add_f32 v28, v28, v36
    v_add_f32 v44, v44, v52
    v_add_f32 v28, v28, v44
    v_mul_f32 v28, v28, v7
    v_add_f32 v29, v29, v37
    v_add_f32 v45, v45, v53
    v_add_f32 v29, v29, v45
    v_mul_f32 v29, v29, v7
    v_add_f32 v30, v30, v38
    v_add_f32 v46, v46, v54
    v_add_f32 v30, v30, v46
    v_mul_f32 v30, v30, v7
    v_add_f32 v31, v31, v39
    v_add_f32 v47, v47, v55
    v_add_f32 v31, v31, v47
    v_mul_f32 v31, v31, v7
    v_add_f32 v32, v32, v40
    v_add_f32 v48, v48, v56
    v_add_f32 v32, v32, v48
    v_mul_f32 v32, v32, v7
    v_add_f32 v33, v33, v41
    v_add_f32 v49, v49, v57
    v_add_f32 v33, v33, v49
    v_mul_f32 v33, v33, v7
    v_add_f32 v34, v34, v42
    v_add_f32 v50, v50, v58
    v_add_f32 v34, v34, v50
    v_mul_f32 v34, v34, v7
    v_add_f32 v35, v35, v43
    v_add_f32 v51, v51, v59
    v_add_f32 v35, v35, v51
    v_mul_f32 v35, v35, v7
    v_cvt_pk_bf16_f32 v40, v28, v29
    v_lshlrev_b32 v41, 16, v40
    v_and_b32 v42, s34, v40
    v_lshlrev_b32 v43, 16, v8
    v_and_b32 v44, s34, v8
    v_add_f32 v41, v41, v43
    v_add_f32 v42, v42, v44
    v_cvt_pk_bf16_f32 v41, v41, v42
    v_and_b32 v42, s34, v41
    v_lshlrev_b32 v41, 16, v41
    v_mul_f32 v41, s42, v41
    v_mul_f32 v42, s42, v42
    v_cvt_pk_bf16_f32 v41, v41, v42
    v_and_b32 v42, s34, v41
    v_lshlrev_b32 v41, 16, v41
    v_lshlrev_b32 v43, 16, v12
    v_and_b32 v44, s34, v12
    v_add_f32 v41, v41, v43
    v_add_f32 v42, v42, v44
    v_cvt_pk_bf16_f32 v48, v41, v42
    v_cvt_pk_bf16_f32 v40, v30, v31
    v_lshlrev_b32 v41, 16, v40
    v_and_b32 v42, s34, v40
    v_lshlrev_b32 v43, 16, v9
    v_and_b32 v44, s34, v9
    v_add_f32 v41, v41, v43
    v_add_f32 v42, v42, v44
    v_cvt_pk_bf16_f32 v41, v41, v42
    v_and_b32 v42, s34, v41
    v_lshlrev_b32 v41, 16, v41
    v_mul_f32 v41, s42, v41
    v_mul_f32 v42, s42, v42
    v_cvt_pk_bf16_f32 v41, v41, v42
    v_and_b32 v42, s34, v41
    v_lshlrev_b32 v41, 16, v41
    v_lshlrev_b32 v43, 16, v13
    v_and_b32 v44, s34, v13
    v_add_f32 v41, v41, v43
    v_add_f32 v42, v42, v44
    v_cvt_pk_bf16_f32 v49, v41, v42
    v_cvt_pk_bf16_f32 v40, v32, v33
    v_lshlrev_b32 v41, 16, v40
    v_and_b32 v42, s34, v40
    v_lshlrev_b32 v43, 16, v10
    v_and_b32 v44, s34, v10
    v_add_f32 v41, v41, v43
    v_add_f32 v42, v42, v44
    v_cvt_pk_bf16_f32 v41, v41, v42
    v_and_b32 v42, s34, v41
    v_lshlrev_b32 v41, 16, v41
    v_mul_f32 v41, s42, v41
    v_mul_f32 v42, s42, v42
    v_cvt_pk_bf16_f32 v41, v41, v42
    v_and_b32 v42, s34, v41
    v_lshlrev_b32 v41, 16, v41
    v_lshlrev_b32 v43, 16, v14
    v_and_b32 v44, s34, v14
    v_add_f32 v41, v41, v43
    v_add_f32 v42, v42, v44
    v_cvt_pk_bf16_f32 v50, v41, v42
    v_cvt_pk_bf16_f32 v40, v34, v35
    v_lshlrev_b32 v41, 16, v40
    v_and_b32 v42, s34, v40
    v_lshlrev_b32 v43, 16, v11
    v_and_b32 v44, s34, v11
    v_add_f32 v41, v41, v43
    v_add_f32 v42, v42, v44
    v_cvt_pk_bf16_f32 v41, v41, v42
    v_and_b32 v42, s34, v41
    v_lshlrev_b32 v41, 16, v41
    v_mul_f32 v41, s42, v41
    v_mul_f32 v42, s42, v42
    v_cvt_pk_bf16_f32 v41, v41, v42
    v_and_b32 v42, s34, v41
    v_lshlrev_b32 v41, 16, v41
    v_lshlrev_b32 v43, 16, v15
    v_and_b32 v44, s34, v15
    v_add_f32 v41, v41, v43
    v_add_f32 v42, v42, v44
    v_cvt_pk_bf16_f32 v51, v41, v42
    buffer_store_dwordx4 v[48:51], v5, s[72:75], 0 offen sc0 sc1
    s_endpgm
pc_done:
    s_endpgm
pc_end:
.section .rodata,"a"
.p2align 6
.amdhsa_kernel pc_kernel
  .amdhsa_next_free_vgpr 128
  .amdhsa_next_free_sgpr 100
  .amdhsa_accum_offset 128
  .amdhsa_group_segment_fixed_size 0
  .amdhsa_kernarg_size 136
  .amdhsa_user_sgpr_count 2
  .amdhsa_user_sgpr_kernarg_segment_ptr 1
  .amdhsa_system_sgpr_workgroup_id_x 1
.end_amdhsa_kernel
.text
.globl g12_kernel
.p2align 8
.type g12_kernel,@function
g12_kernel:
    s_load_dwordx2 s[14:15], s[0:1], 128
    s_mov_b32 s16, s2
    s_memrealtime s[58:59]
    s_cmp_ge_u32 s16, 256
    s_cbranch_scc1 g1_done
    s_cmp_lt_u32 s16, 224
    s_cbranch_scc1 g12_go
    s_getpc_b64 s[84:85]
cw_pc1:
    s_add_u32 s84, s84, g12_go-cw_pc1
    s_addc_u32 s85, s85, 0
    s_mov_b32 s86, g12_end-g12_go
    s_mov_b32 s87, 0x00020000
    v_lshlrev_b32 v7, 7, v0
    buffer_load_dword v94, v7, s[84:87], 0 offen
g12_go:
    s_and_b32 s20, s16, 6
    s_lshr_b32 s21, s16, 3
    s_and_b32 s22, s21, 3
    s_lshl_b32 s20, s20, 1
    s_add_u32 s20, s20, s22
    s_lshr_b32 s53, s21, 2
    s_and_b32 s52, s16, 7
    s_lshl_b32 s52, s52, 2
    s_add_u32 s52, s52, s22
    s_lshr_b32 s21, s21, 2
    s_and_b32 s22, s16, 1
    s_mul_i32 s22, s22, 7
    s_add_u32 s21, s21, s22
    v_and_b32 v1, 63, v0
    v_lshrrev_b32 v2, 6, v0
    s_lshl_b32 s24, s20, 8
    v_readfirstlane_b32 s26, v2
    v_lshrrev_b32 v3, 4, v1
    v_and_b32 v4, 15, v1
    s_cmp_ge_u32 s26, 4
    s_cbranch_scc1 g1_load
    s_cmp_ge_u32 s16, 224
    s_cbranch_scc1 g1_cidle
    s_lshl_b32 s25, s21, 2
    s_add_u32 s25, s25, s26
    s_mul_i32 s27, s25, 43008
    v_lshlrev_b32 v16, 4, v1
    s_mov_b32 s34, 2322432
    s_mov_b32 s35, 0x00020000
    s_add_u32 s28, s27, 4096
    s_waitcnt lgkmcnt(0)
    s_add_u32 s32, s14, 23560192
    s_addc_u32 s33, s15, 0
    buffer_load_dwordx4 v[160:163], v16, s[32:35], s27 offen offset:0
    buffer_load_dwordx4 v[164:167], v16, s[32:35], s27 offen offset:1024
    buffer_load_dwordx4 v[168:171], v16, s[32:35], s27 offen offset:2048
    buffer_load_dwordx4 v[172:175], v16, s[32:35], s27 offen offset:3072
    buffer_load_dwordx4 v[176:179], v16, s[32:35], s28 offen offset:0
    buffer_load_dwordx4 v[180:183], v16, s[32:35], s28 offen offset:1024
    buffer_load_dwordx4 v[184:187], v16, s[32:35], s28 offen offset:2048
    buffer_load_dwordx4 v[188:191], v16, s[32:35], s28 offen offset:3072
    s_branch g1_compute
g1_load:
    s_cmp_ge_u32 s16, 224
    s_cbranch_scc1 g1_lidle
    v_subrev_u32 v5, 4, v2
    v_lshlrev_b32 v5, 3, v5
    v_add_u32 v5, v5, v3
    v_lshlrev_b32 v6, 1, v3
    v_xor_b32 v10, v4, v6
    v_add_u32 v6, 8, v6
    v_xor_b32 v6, v4, v6
    v_lshlrev_b32 v10, 4, v10
    v_lshlrev_b32 v6, 4, v6
    v_mul_u32_u24 v12, 4352, v5
    v_add_u32 v8, v12, v10
    v_add3_u32 v9, v12, v6, 0
    v_add_u32 v9, 17408, v9
    s_sub_u32 s27, s26, 4
    s_lshl_b32 s27, s27, 11
    s_mov_b32 s30, 2785280
    s_mov_b32 s31, 0x00020000
    s_waitcnt lgkmcnt(0)
    s_add_u32 s28, s14, 8257536
    s_addc_u32 s29, s15, 0
    s_add_u32 s38, s24, 0
    s_add_u32 m0, s27, 0
    s_nop 0
    buffer_load_dwordx4 v8, s[28:31], s38 offen lds
    s_add_u32 m0, s27, 1024
    s_nop 0
    buffer_load_dwordx4 v9, s[28:31], s38 offen lds
    s_add_u32 s38, s24, 139264
    s_add_u32 m0, s27, 8192
    s_nop 0
    buffer_load_dwordx4 v8, s[28:31], s38 offen lds
    s_add_u32 m0, s27, 9216
    s_nop 0
    buffer_load_dwordx4 v9, s[28:31], s38 offen lds
    s_add_u32 s38, s24, 278528
    s_add_u32 m0, s27, 16384
    s_nop 0
    buffer_load_dwordx4 v8, s[28:31], s38 offen lds
    s_add_u32 m0, s27, 17408
    s_nop 0
    buffer_load_dwordx4 v9, s[28:31], s38 offen lds
    s_add_u32 s38, s24, 417792
    s_add_u32 m0, s27, 24576
    s_nop 0
    buffer_load_dwordx4 v8, s[28:31], s38 offen lds
    s_add_u32 m0, s27, 25600
    s_nop 0
    buffer_load_dwordx4 v9, s[28:31], s38 offen lds
    s_add_u32 s38, s24, 557056
    s_add_u32 m0, s27, 32768
    s_nop 0
    buffer_load_dwordx4 v8, s[28:31], s38 offen lds
    s_add_u32 m0, s27, 33792
    s_nop 0
    buffer_load_dwordx4 v9, s[28:31], s38 offen lds
    s_add_u32 s38, s24, 696320
    s_add_u32 m0, s27, 40960
    s_nop 0
    buffer_load_dwordx4 v8, s[28:31], s38 offen lds
    s_add_u32 m0, s27, 41984
    s_nop 0
    buffer_load_dwordx4 v9, s[28:31], s38 offen lds
    s_load_dwordx2 s[10:11], s[0:1], 112
    s_and_b32 s54, s26, 3
    s_lshr_b32 s55, s26, 2
    s_add_u32 s60, s14, 21348352
    s_addc_u32 s61, s15, 0
    s_mov_b32 s62, 2211840
    s_mov_b32 s63, 0x00020000
    s_add_u32 s64, s14, 21348352
    s_addc_u32 s65, s15, 0
    s_mov_b32 s66, 2211840
    s_mov_b32 s67, 0x00020000
    s_add_u32 s68, s14, 13828096
    s_addc_u32 s69, s15, 0
    s_mov_b32 s70, 7077888
    s_mov_b32 s71, 0x00020000
    s_add_u32 s72, s14, 13828096
    s_addc_u32 s73, s15, 0
    s_mov_b32 s74, 7077888
    s_mov_b32 s75, 0x00020000
    s_cmp_lt_u32 s54, 2
    s_cselect_b32 s66, s66, 0
    s_cselect_b32 s74, s74, 0
    s_mul_i32 s88, s54, 14
    s_cmp_eq_u32 s54, 3
    s_subb_u32 s88, s88, 0
    s_mul_i32 s76, s53, 54
    s_add_u32 s76, s76, s88
    s_mul_i32 s76, s76, 5120
    s_lshl_b32 s89, s55, 1
    s_add_u32 s89, s89, s54
    s_and_b32 s89, s89, 3
    s_lshl_b32 s90, s52, 2
    s_add_u32 s89, s89, s90
    s_mul_i32 s89, s89, 54
    s_add_u32 s89, s89, s88
    s_lshl_b32 s77, s89, 10
    s_lshl_b32 s89, s55, 1
    s_add_u32 s89, s89, s54
    s_add_u32 s89, s89, 1
    s_and_b32 s89, s89, 3
    s_lshl_b32 s90, s52, 2
    s_add_u32 s89, s89, s90
    s_mul_i32 s89, s89, 54
    s_add_u32 s89, s89, s88
    s_lshl_b32 s78, s89, 10
    s_lshl_b32 s79, s54, 1
    s_add_u32 s79, s79, s55
    s_mul_i32 s79, s79, 20480
    v_and_b32 v1, 63, v0
    v_lshlrev_b32 v1, 4, v1
    s_mul_i32 s88, s54, 40960
    v_add_u32 v4, s88, v1
    s_add_u32 s80, s14, 11042816
    s_addc_u32 s81, s15, 0
    s_mov_b32 s82, 65536
    s_mov_b32 s83, 0x00020000
    s_load_dwordx2 s[56:57], s[14:15], 32768
    v_lshlrev_b32 v12, 4, v0
    v_mov_b32 v28, 0
    v_mov_b32 v29, 0
    v_mov_b32 v30, 0
    v_mov_b32 v31, 0
    v_add_u32 v12, 131072, v12
    ds_write_b128 v12, v[28:31]
    s_waitcnt lgkmcnt(0)
    s_waitcnt vmcnt(8)
    s_barrier
    s_add_u32 s38, s24, 835584
    s_add_u32 m0, s27, 49152
    s_nop 0
    buffer_load_dwordx4 v8, s[28:31], s38 offen lds
    s_add_u32 m0, s27, 50176
    s_nop 0
    buffer_load_dwordx4 v9, s[28:31], s38 offen lds
    s_add_u32 s38, s24, 974848
    s_add_u32 m0, s27, 57344
    s_nop 0
    buffer_load_dwordx4 v8, s[28:31], s38 offen lds
    s_add_u32 m0, s27, 58368
    s_nop 0
    buffer_load_dwordx4 v9, s[28:31], s38 offen lds
    s_waitcnt vmcnt(8)
    s_barrier
    s_add_u32 s38, s24, 1114112
    s_add_u32 m0, s27, 65536
    s_nop 0
    buffer_load_dwordx4 v8, s[28:31], s38 offen lds
    s_add_u32 m0, s27, 66560
    s_nop 0
    buffer_load_dwordx4 v9, s[28:31], s38 offen lds
    s_add_u32 s38, s24, 1253376
    s_add_u32 m0, s27, 73728
    s_nop 0
    buffer_load_dwordx4 v8, s[28:31], s38 offen lds
    s_add_u32 m0, s27, 74752
    s_nop 0
    buffer_load_dwordx4 v9, s[28:31], s38 offen lds
    s_waitcnt vmcnt(8)
    s_barrier
    s_add_u32 s38, s24, 1392640
    s_add_u32 m0, s27, 81920
    s_nop 0
    buffer_load_dwordx4 v8, s[28:31], s38 offen lds
    s_add_u32 m0, s27, 82944
    s_nop 0
    buffer_load_dwordx4 v9, s[28:31], s38 offen lds
    s_add_u32 s38, s24, 1531904
    s_add_u32 m0, s27, 90112
    s_nop 0
    buffer_load_dwordx4 v8, s[28:31], s38 offen lds
    s_add_u32 m0, s27, 91136
    s_nop 0
    buffer_load_dwordx4 v9, s[28:31], s38 offen lds
    s_add_u32 s38, s24, 1671168
    s_add_u32 m0, s27, 98304
    s_nop 0
    buffer_load_dwordx4 v8, s[28:31], s38 offen lds
    s_add_u32 m0, s27, 99328
    s_nop 0
    buffer_load_dwordx4 v9, s[28:31], s38 offen lds
    s_add_u32 s38, s24, 1810432
    s_add_u32 m0, s27, 106496
    s_nop 0
    buffer_load_dwordx4 v8, s[28:31], s38 offen lds
    s_add_u32 m0, s27, 107520
    s_nop 0
    buffer_load_dwordx4 v9, s[28:31], s38 offen lds
    s_waitcnt vmcnt(12)
    s_barrier
    s_add_u32 s38, s24, 1949696
    s_add_u32 m0, s27, 114688
    s_nop 0
    buffer_load_dwordx4 v8, s[28:31], s38 offen lds
    s_add_u32 m0, s27, 115712
    s_nop 0
    buffer_load_dwordx4 v9, s[28:31], s38 offen lds
    s_add_u32 s38, s24, 2088960
    s_add_u32 m0, s27, 122880
    s_nop 0
    buffer_load_dwordx4 v8, s[28:31], s38 offen lds
    s_add_u32 m0, s27, 123904
    s_nop 0
    buffer_load_dwordx4 v9, s[28:31], s38 offen lds
    s_waitcnt vmcnt(12)
    s_barrier
    s_add_u32 s38, s24, 2228224
    s_add_u32 m0, s27, 0
    s_nop 0
    buffer_load_dwordx4 v8, s[28:31], s38 offen lds
    s_add_u32 m0, s27, 1024
    s_nop 0
    buffer_load_dwordx4 v9, s[28:31], s38 offen lds
    s_add_u32 s38, s24, 2367488
    s_add_u32 m0, s27, 8192
    s_nop 0
    buffer_load_dwordx4 v8, s[28:31], s38 offen lds
    s_add_u32 m0, s27, 9216
    s_nop 0
    buffer_load_dwordx4 v9, s[28:31], s38 offen lds
    s_waitcnt vmcnt(8)
    s_barrier
    s_add_u32 s38, s24, 2506752
    s_add_u32 m0, s27, 16384
    s_nop 0
    buffer_load_dwordx4 v8, s[28:31], s38 offen lds
    s_add_u32 m0, s27, 17408
    s_nop 0
    buffer_load_dwordx4 v9, s[28:31], s38 offen lds
    s_add_u32 s38, s24, 2646016
    s_add_u32 m0, s27, 24576
    s_nop 0
    buffer_load_dwordx4 v8, s[28:31], s38 offen lds
    s_add_u32 m0, s27, 25600
    s_nop 0
    buffer_load_dwordx4 v9, s[28:31], s38 offen lds
    s_add_u32 m0, s27, 139264
    s_add_u32 s88, s76, 3072
    buffer_load_dwordx4 v1, s[60:63], s88 offen offset:0 lds
    buffer_load_dwordx4 v1, s[60:63], s88 offen offset:1024 lds
    s_add_u32 m0, s27, 147456
    s_add_u32 s88, s76, 8192
    buffer_load_dwordx4 v1, s[60:63], s88 offen offset:0 lds
    buffer_load_dwordx4 v1, s[60:63], s88 offen offset:1024 lds
    s_add_u32 m0, s27, 155648
    s_add_u32 s88, s76, 13312
    buffer_load_dwordx4 v1, s[60:63], s88 offen offset:0 lds
    buffer_load_dwordx4 v1, s[60:63], s88 offen offset:1024 lds
    s_waitcnt vmcnt(6)
    s_barrier
    s_waitcnt vmcnt(8)
    s_add_u32 m0, s27, 32768
    s_add_u32 s88, s76, 18432
    buffer_load_dwordx4 v1, s[60:63], s88 offen offset:0 lds
    buffer_load_dwordx4 v1, s[60:63], s88 offen offset:1024 lds
    s_waitcnt vmcnt(8)
    s_add_u32 s88, s76, 0
    buffer_load_dwordx4 v[88:91], v1, s[60:63], s88 offen offset:0
    buffer_load_dwordx4 v[92:95], v1, s[60:63], s88 offen offset:1024
    buffer_load_dwordx4 v[96:99], v1, s[60:63], s88 offen offset:2048
    s_waitcnt vmcnt(8)
    s_add_u32 m0, s27, 40960
    s_add_u32 s88, s76, 23552
    buffer_load_dwordx4 v1, s[60:63], s88 offen offset:0 lds
    buffer_load_dwordx4 v1, s[60:63], s88 offen offset:1024 lds
    s_waitcnt vmcnt(8)
    s_add_u32 s88, s76, 5120
    buffer_load_dwordx4 v[100:103], v1, s[60:63], s88 offen offset:0
    buffer_load_dwordx4 v[104:107], v1, s[60:63], s88 offen offset:1024
    buffer_load_dwordx4 v[108:111], v1, s[60:63], s88 offen offset:2048
    s_waitcnt vmcnt(8)
    s_add_u32 m0, s27, 49152
    s_add_u32 s88, s76, 28672
    buffer_load_dwordx4 v1, s[60:63], s88 offen offset:0 lds
    buffer_load_dwordx4 v1, s[60:63], s88 offen offset:1024 lds
    s_waitcnt vmcnt(8)
    s_add_u32 s88, s76, 10240
    buffer_load_dwordx4 v[112:115], v1, s[60:63], s88 offen offset:0
    buffer_load_dwordx4 v[116:119], v1, s[60:63], s88 offen offset:1024
    buffer_load_dwordx4 v[120:123], v1, s[60:63], s88 offen offset:2048
    s_waitcnt vmcnt(8)
    s_add_u32 m0, s27, 57344
    s_add_u32 s88, s76, 33792
    buffer_load_dwordx4 v1, s[60:63], s88 offen offset:0 lds
    buffer_load_dwordx4 v1, s[60:63], s88 offen offset:1024 lds
    s_waitcnt vmcnt(8)
    s_add_u32 s88, s76, 15360
    buffer_load_dwordx4 v[124:127], v1, s[60:63], s88 offen offset:0
    buffer_load_dwordx4 v[128:131], v1, s[60:63], s88 offen offset:1024
    buffer_load_dwordx4 v[132:135], v1, s[60:63], s88 offen offset:2048
    s_waitcnt vmcnt(8)
    s_add_u32 m0, s27, 65536
    s_add_u32 s88, s76, 38912
    buffer_load_dwordx4 v1, s[60:63], s88 offen offset:0 lds
    buffer_load_dwordx4 v1, s[60:63], s88 offen offset:1024 lds
    s_waitcnt vmcnt(8)
    s_add_u32 s88, s76, 20480
    buffer_load_dwordx4 v[136:139], v1, s[60:63], s88 offen offset:0
    buffer_load_dwordx4 v[140:143], v1, s[60:63], s88 offen offset:1024
    buffer_load_dwordx4 v[144:147], v1, s[60:63], s88 offen offset:2048
    s_waitcnt vmcnt(8)
    s_add_u32 s88, s76, 25600
    buffer_load_dwordx4 v[148:151], v1, s[60:63], s88 offen offset:0
    buffer_load_dwordx4 v[152:155], v1, s[60:63], s88 offen offset:1024
    buffer_load_dwordx4 v[156:159], v1, s[60:63], s88 offen offset:2048
    s_waitcnt vmcnt(8)
    s_add_u32 s88, s76, 30720
    buffer_load_dwordx4 v[160:163], v1, s[60:63], s88 offen offset:0
    buffer_load_dwordx4 v[164:167], v1, s[60:63], s88 offen offset:1024
    buffer_load_dwordx4 v[168:171], v1, s[60:63], s88 offen offset:2048
    s_cmp_eq_u32 s26, 4
    s_cbranch_scc1 g1_l4
    s_waitcnt vmcnt(0)
    s_barrier
    s_add_u32 s88, s76, 35840
    buffer_load_dwordx4 v[172:175], v1, s[60:63], s88 offen offset:0
    buffer_load_dwordx4 v[176:179], v1, s[60:63], s88 offen offset:1024
    buffer_load_dwordx4 v[180:183], v1, s[60:63], s88 offen offset:2048
    s_add_u32 s88, s76, 40960
    buffer_load_dwordx4 v[184:187], v1, s[60:63], s88 offen offset:0
    buffer_load_dwordx4 v[188:191], v1, s[60:63], s88 offen offset:1024
    buffer_load_dwordx4 v[192:195], v1, s[60:63], s88 offen offset:2048
    s_add_u32 s88, s76, 46080
    buffer_load_dwordx4 v[196:199], v1, s[60:63], s88 offen offset:0
    buffer_load_dwordx4 v[200:203], v1, s[60:63], s88 offen offset:1024
    buffer_load_dwordx4 v[204:207], v1, s[60:63], s88 offen offset:2048
    s_add_u32 s88, s76, 51200
    buffer_load_dwordx4 v[208:211], v1, s[60:63], s88 offen offset:0
    buffer_load_dwordx4 v[212:215], v1, s[60:63], s88 offen offset:1024
    buffer_load_dwordx4 v[216:219], v1, s[60:63], s88 offen offset:2048
    s_branch g2_lwait
g1_l4:
    s_add_u32 s88, s76, 35840
    buffer_load_dwordx4 v[172:175], v1, s[60:63], s88 offen offset:0
    buffer_load_dwordx4 v[176:179], v1, s[60:63], s88 offen offset:1024
    buffer_load_dwordx4 v[180:183], v1, s[60:63], s88 offen offset:2048
    s_add_u32 s88, s76, 40960
    buffer_load_dwordx4 v[184:187], v1, s[60:63], s88 offen offset:0
    buffer_load_dwordx4 v[188:191], v1, s[60:63], s88 offen offset:1024
    buffer_load_dwordx4 v[192:195], v1, s[60:63], s88 offen offset:2048
    s_add_u32 s88, s76, 46080
    buffer_load_dwordx4 v[196:199], v1, s[60:63], s88 offen offset:0
    buffer_load_dwordx4 v[200:203], v1, s[60:63], s88 offen offset:1024
    buffer_load_dwordx4 v[204:207], v1, s[60:63], s88 offen offset:2048
    s_add_u32 s88, s76, 51200
    buffer_load_dwordx4 v[208:211], v1, s[60:63], s88 offen offset:0
    buffer_load_dwordx4 v[212:215], v1, s[60:63], s88 offen offset:1024
    buffer_load_dwordx4 v[216:219], v1, s[60:63], s88 offen offset:2048
    s_waitcnt vmcnt(12)
    s_barrier
    s_branch g2_poll
g1_lidle:
    s_waitcnt lgkmcnt(0)
    s_load_dwordx2 s[10:11], s[0:1], 112
    s_and_b32 s54, s26, 3
    s_lshr_b32 s55, s26, 2
    s_add_u32 s60, s14, 21348352
    s_addc_u32 s61, s15, 0
    s_mov_b32 s62, 2211840
    s_mov_b32 s63, 0x00020000
    s_add_u32 s64, s14, 21348352
    s_addc_u32 s65, s15, 0
    s_mov_b32 s66, 2211840
    s_mov_b32 s67, 0x00020000
    s_add_u32 s68, s14, 13828096
    s_addc_u32 s69, s15, 0
    s_mov_b32 s70, 7077888
    s_mov_b32 s71, 0x00020000
    s_add_u32 s72, s14, 13828096
    s_addc_u32 s73, s15, 0
    s_mov_b32 s74, 7077888
    s_mov_b32 s75, 0x00020000
    s_cmp_lt_u32 s54, 2
    s_cselect_b32 s66, s66, 0
    s_cselect_b32 s74, s74, 0
    s_mul_i32 s88, s54, 14
    s_cmp_eq_u32 s54, 3
    s_subb_u32 s88, s88, 0
    s_mul_i32 s76, s53, 54
    s_add_u32 s76, s76, s88
    s_mul_i32 s76, s76, 5120
    s_lshl_b32 s89, s55, 1
    s_add_u32 s89, s89, s54
    s_and_b32 s89, s89, 3
    s_lshl_b32 s90, s52, 2
    s_add_u32 s89, s89, s90
    s_mul_i32 s89, s89, 54
    s_add_u32 s89, s89, s88
    s_lshl_b32 s77, s89, 10
    s_lshl_b32 s89, s55, 1
    s_add_u32 s89, s89, s54
    s_add_u32 s89, s89, 1
    s_and_b32 s89, s89, 3
    s_lshl_b32 s90, s52, 2
    s_add_u32 s89, s89, s90
    s_mul_i32 s89, s89, 54
    s_add_u32 s89, s89, s88
    s_lshl_b32 s78, s89, 10
    s_lshl_b32 s79, s54, 1
    s_add_u32 s79, s79, s55
    s_mul_i32 s79, s79, 20480
    v_and_b32 v1, 63, v0
    v_lshlrev_b32 v1, 4, v1
    s_mul_i32 s88, s54, 40960
    v_add_u32 v4, s88, v1
    s_add_u32 s80, s14, 11042816
    s_addc_u32 s81, s15, 0
    s_mov_b32 s82, 65536
    s_mov_b32 s83, 0x00020000
    s_load_dwordx2 s[56:57], s[14:15], 32768
    s_add_u32 s88, s76, 0
    buffer_load_dwordx4 v[88:91], v1, s[60:63], s88 offen offset:0
    buffer_load_dwordx4 v[92:95], v1, s[60:63], s88 offen offset:1024
    buffer_load_dwordx4 v[96:99], v1, s[60:63], s88 offen offset:2048
    s_add_u32 s88, s76, 5120
    buffer_load_dwordx4 v[100:103], v1, s[60:63], s88 offen offset:0
    buffer_load_dwordx4 v[104:107], v1, s[60:63], s88 offen offset:1024
    buffer_load_dwordx4 v[108:111], v1, s[60:63], s88 offen offset:2048
    s_add_u32 s88, s76, 10240
    buffer_load_dwordx4 v[112:115], v1, s[60:63], s88 offen offset:0
    buffer_load_dwordx4 v[116:119], v1, s[60:63], s88 offen offset:1024
    buffer_load_dwordx4 v[120:123], v1, s[60:63], s88 offen offset:2048
    s_add_u32 s88, s76, 15360
    buffer_load_dwordx4 v[124:127], v1, s[60:63], s88 offen offset:0
    buffer_load_dwordx4 v[128:131], v1, s[60:63], s88 offen offset:1024
    buffer_load_dwordx4 v[132:135], v1, s[60:63], s88 offen offset:2048
    s_add_u32 s88, s76, 20480
    buffer_load_dwordx4 v[136:139], v1, s[60:63], s88 offen offset:0
    buffer_load_dwordx4 v[140:143], v1, s[60:63], s88 offen offset:1024
    buffer_load_dwordx4 v[144:147], v1, s[60:63], s88 offen offset:2048
    s_add_u32 s88, s76, 25600
    buffer_load_dwordx4 v[148:151], v1, s[60:63], s88 offen offset:0
    buffer_load_dwordx4 v[152:155], v1, s[60:63], s88 offen offset:1024
    buffer_load_dwordx4 v[156:159], v1, s[60:63], s88 offen offset:2048
    s_add_u32 s88, s76, 30720
    buffer_load_dwordx4 v[160:163], v1, s[60:63], s88 offen offset:0
    buffer_load_dwordx4 v[164:167], v1, s[60:63], s88 offen offset:1024
    buffer_load_dwordx4 v[168:171], v1, s[60:63], s88 offen offset:2048
    s_add_u32 s88, s76, 35840
    buffer_load_dwordx4 v[172:175], v1, s[60:63], s88 offen offset:0
    buffer_load_dwordx4 v[176:179], v1, s[60:63], s88 offen offset:1024
    buffer_load_dwordx4 v[180:183], v1, s[60:63], s88 offen offset:2048
    s_add_u32 s88, s76, 40960
    buffer_load_dwordx4 v[184:187], v1, s[60:63], s88 offen offset:0
    buffer_load_dwordx4 v[188:191], v1, s[60:63], s88 offen offset:1024
    buffer_load_dwordx4 v[192:195], v1, s[60:63], s88 offen offset:2048
    s_add_u32 s88, s76, 46080
    buffer_load_dwordx4 v[196:199], v1, s[60:63], s88 offen offset:0
    buffer_load_dwordx4 v[200:203], v1, s[60:63], s88 offen offset:1024
    buffer_load_dwordx4 v[204:207], v1, s[60:63], s88 offen offset:2048
    s_add_u32 s88, s76, 51200
    buffer_load_dwordx4 v[208:211], v1, s[60:63], s88 offen offset:0
    buffer_load_dwordx4 v[212:215], v1, s[60:63], s88 offen offset:1024
    buffer_load_dwordx4 v[216:219], v1, s[60:63], s88 offen offset:2048
    s_cmp_lg_u32 s26, 4
    s_cbranch_scc1 g2_lwait
    s_mov_b32 s45, 0
g2_gate:
    s_sleep 8
    s_memrealtime s[40:41]
    s_add_u32 s45, s45, 1
    s_waitcnt lgkmcnt(0)
    s_sub_u32 s40, s40, s58
    s_cmp_ge_u32 s40, 700
    s_cbranch_scc1 g2_poll
    s_cmp_lt_u32 s45, 64
    s_cbranch_scc1 g2_gate
g2_poll:
    s_lshr_b32 s23, s52, 1
    s_and_b32 s22, s53, 31
    s_lshl_b32 s22, s22, 4
    s_add_u32 s22, s22, s23
    s_lshl_b32 s22, s22, 7
    v_lshlrev_b32 v8, 3, v1
    v_lshrrev_b32 v8, 4, v8
    s_mov_b32 s45, 0
    s_waitcnt lgkmcnt(0)
    s_lshl_b32 s91, s23, 7
    s_add_u32 s91, s91, 11042816
    s_mov_b32 s92, 0
g2_sl:
    s_memrealtime s[94:95]
    s_waitcnt lgkmcnt(0)
    s_bfe_u32 s93, s94, 327683
    s_lshl_b32 s93, s93, 11
    s_add_u32 s93, s93, s91
    s_load_dwordx16 s[36:51], s[14:15], s93 glc
    s_load_dwordx8 s[28:35], s[14:15], s93 offset:64 glc
    s_load_dwordx4 s[84:87], s[14:15], s93 offset:96 glc
    s_add_u32 s92, s92, 1
    s_waitcnt lgkmcnt(0)
    s_cmp_eq_u64 s[36:37], s[56:57]
    s_cbranch_scc0 g2_sn
    s_cmp_eq_u64 s[38:39], s[56:57]
    s_cbranch_scc0 g2_sn
    s_cmp_eq_u64 s[40:41], s[56:57]
    s_cbranch_scc0 g2_sn
    s_cmp_eq_u64 s[42:43], s[56:57]
    s_cbranch_scc0 g2_sn
    s_cmp_eq_u64 s[44:45], s[56:57]
    s_cbranch_scc0 g2_sn
    s_cmp_eq_u64 s[46:47], s[56:57]
    s_cbranch_scc0 g2_sn
    s_cmp_eq_u64 s[48:49], s[56:57]
    s_cbranch_scc0 g2_sn
    s_cmp_eq_u64 s[50:51], s[56:57]
    s_cbranch_scc0 g2_sn
    s_cmp_eq_u64 s[28:29], s[56:57]
    s_cbranch_scc0 g2_sn
    s_cmp_eq_u64 s[30:31], s[56:57]
    s_cbranch_scc0 g2_sn
    s_cmp_eq_u64 s[32:33], s[56:57]
    s_cbranch_scc0 g2_sn
    s_cmp_eq_u64 s[34:35], s[56:57]
    s_cbranch_scc0 g2_sn
    s_cmp_eq_u64 s[84:85], s[56:57]
    s_cbranch_scc0 g2_sn
    s_cmp_eq_u64 s[86:87], s[56:57]
    s_cbranch_scc0 g2_sn
    s_branch g2_lwait
g2_sn:
    s_cmp_lt_u32 s92, 24
    s_cbranch_scc1 g2_sl
    s_mov_b32 s45, 0
    s_mov_b64 exec, 16383
g2_loop:
    buffer_load_dwordx2 v[10:11], v8, s[80:83], s22 offen sc1
    s_waitcnt vmcnt(0)
    v_cmp_eq_u64 vcc, s[56:57], v[10:11]
    s_cmp_eq_u32 vcc_lo, 16383
    s_cbranch_scc1 g2_ok
    s_sleep 2
    s_add_u32 s45, s45, 1
    s_cmp_lt_u32 s45, 32768
    s_cbranch_scc1 g2_loop
g2_ok:
    s_mov_b64 exec, -1
g2_lwait:
    s_barrier
    s_add_u32 m0, s79, 0
    s_add_u32 s88, s77, 0
    buffer_load_dwordx4 v1, s[68:71], s88 offen sc1 lds
    s_add_u32 m0, s79, 10240
    s_add_u32 s88, s78, 0
    buffer_load_dwordx4 v1, s[68:71], s88 offen sc1 lds
    s_add_u32 m0, s79, 1024
    s_add_u32 s88, s77, 1024
    buffer_load_dwordx4 v1, s[68:71], s88 offen sc1 lds
    s_add_u32 m0, s79, 11264
    s_add_u32 s88, s78, 1024
    buffer_load_dwordx4 v1, s[68:71], s88 offen sc1 lds
    s_add_u32 m0, s79, 2048
    s_add_u32 s88, s77, 2048
    buffer_load_dwordx4 v1, s[68:71], s88 offen sc1 lds
    s_add_u32 m0, s79, 12288
    s_add_u32 s88, s78, 2048
    buffer_load_dwordx4 v1, s[68:71], s88 offen sc1 lds
    s_add_u32 m0, s79, 3072
    s_add_u32 s88, s77, 3072
    buffer_load_dwordx4 v1, s[68:71], s88 offen sc1 lds
    s_add_u32 m0, s79, 13312
    s_add_u32 s88, s78, 3072
    buffer_load_dwordx4 v1, s[68:71], s88 offen sc1 lds
    s_add_u32 m0, s79, 4096
    s_add_u32 s88, s77, 4096
    buffer_load_dwordx4 v1, s[68:71], s88 offen sc1 lds
    s_add_u32 m0, s79, 14336
    s_add_u32 s88, s78, 4096
    buffer_load_dwordx4 v1, s[68:71], s88 offen sc1 lds
    s_add_u32 s28, s14, 8257536
    s_addc_u32 s29, s15, 0
    s_mov_b32 s30, 2785280
    s_mov_b32 s31, 0x00020000
    s_mov_b32 s32, s14
    s_mov_b32 s33, s15
    s_mov_b32 s34, 15360
    s_mov_b32 s35, 0x00020000
    s_waitcnt lgkmcnt(0)
    s_mov_b32 s36, s10
    s_mov_b32 s37, s11
    s_mov_b32 s38, 2621440
    s_mov_b32 s39, 0x00020000
    v_lshrrev_b32 v5, 8, v1
    v_bfe_u32 v6, v1, 4, 4
    s_lshl_b32 s20, s52, 2
    s_add_u32 s20, s20, s54
    s_lshl_b32 s20, s20, 4
    s_mul_i32 s21, s53, 80
    s_add_u32 s21, s21, 0
    v_lshlrev_b32 v3, 4, v5
    v_lshrrev_b32 v2, 5, v1
    v_mul_u32_u24 v2, 4352, v2
    v_and_b32 v7, 16, v1
    v_add_u32 v2, v2, v7
    s_mul_i32 s26, s54, 40960
    s_mul_i32 s22, s21, 4352
    s_lshl_b32 s23, s20, 1
    s_add_u32 s22, s22, s23
    s_lshl_b32 s23, s21, 2
    s_add_u32 s23, s23, 12800
    s_mul_i32 s24, s20, 1280
    s_lshl_b32 s25, s21, 1
    s_add_u32 s24, s24, s25
    v_mul_u32_u24 v7, 1280, v6
    v_lshl_add_u32 v6, v5, 4, v7
    v_lshl_add_u32 v7, v5, 3, v7
    v_lshrrev_b32 v5, 1, v1
    v_sub_u32 v5, v4, v5
    s_waitcnt vmcnt(8)
    s_barrier
    ds_read_b128 v[12:15], v4 offset:10240
    ds_read_b128 v[16:19], v4 offset:20480
    ds_read_b128 v[20:23], v4 offset:30720
    ds_read_b128 v[8:11], v4 offset:0
    s_waitcnt lgkmcnt(3)
    v_mfma_f32_16x16x32_bf16 v[52:55], v[88:91], v[12:15], 0
    s_add_u32 m0, s79, 5120
    s_add_u32 s88, s77, 5120
    buffer_load_dwordx4 v1, s[68:71], s88 offen sc1 lds
    v_mfma_f32_16x16x32_bf16 v[56:59], v[92:95], v[12:15], 0
    s_add_u32 m0, s79, 15360
    s_add_u32 s88, s78, 5120
    buffer_load_dwordx4 v1, s[68:71], s88 offen sc1 lds
    v_mfma_f32_16x16x32_bf16 v[60:63], v[96:99], v[12:15], 0
    s_waitcnt lgkmcnt(2)
    v_mfma_f32_16x16x32_bf16 v[64:67], v[88:91], v[16:19], 0
    v_mfma_f32_16x16x32_bf16 v[68:71], v[92:95], v[16:19], 0
    v_mfma_f32_16x16x32_bf16 v[72:75], v[96:99], v[16:19], 0
    s_waitcnt vmcnt(8)
    s_barrier
    s_waitcnt lgkmcnt(1)
    v_mfma_f32_16x16x32_bf16 v[76:79], v[88:91], v[20:23], 0
    ds_read_b128 v[28:31], v4 offset:11264
    v_mfma_f32_16x16x32_bf16 v[80:83], v[92:95], v[20:23], 0
    ds_read_b128 v[32:35], v4 offset:21504
    v_mfma_f32_16x16x32_bf16 v[84:87], v[96:99], v[20:23], 0
    ds_read_b128 v[36:39], v4 offset:31744
    s_waitcnt lgkmcnt(3)
    v_mfma_f32_16x16x32_bf16 v[40:43], v[88:91], v[8:11], 0
    ds_read_b128 v[24:27], v4 offset:1024
    v_mfma_f32_16x16x32_bf16 v[44:47], v[92:95], v[8:11], 0
    v_mfma_f32_16x16x32_bf16 v[48:51], v[96:99], v[8:11], 0
    s_waitcnt lgkmcnt(3)
    v_mfma_f32_16x16x32_bf16 v[52:55], v[100:103], v[28:31], v[52:55]
    s_add_u32 m0, s79, 6144
    s_add_u32 s88, s77, 6144
    buffer_load_dwordx4 v1, s[68:71], s88 offen sc1 lds
    v_mfma_f32_16x16x32_bf16 v[56:59], v[104:107], v[28:31], v[56:59]
    s_add_u32 m0, s79, 16384
    s_add_u32 s88, s78, 6144
    buffer_load_dwordx4 v1, s[68:71], s88 offen sc1 lds
    v_mfma_f32_16x16x32_bf16 v[60:63], v[108:111], v[28:31], v[60:63]
    s_waitcnt lgkmcnt(2)
    v_mfma_f32_16x16x32_bf16 v[64:67], v[100:103], v[32:35], v[64:67]
    v_mfma_f32_16x16x32_bf16 v[68:71], v[104:107], v[32:35], v[68:71]
    v_mfma_f32_16x16x32_bf16 v[72:75], v[108:111], v[32:35], v[72:75]
    s_waitcnt vmcnt(8)
    s_barrier
    s_waitcnt lgkmcnt(1)
    v_mfma_f32_16x16x32_bf16 v[76:79], v[100:103], v[36:39], v[76:79]
    ds_read_b128 v[12:15], v4 offset:12288
    v_mfma_f32_16x16x32_bf16 v[80:83], v[104:107], v[36:39], v[80:83]
    ds_read_b128 v[16:19], v4 offset:22528
    v_mfma_f32_16x16x32_bf16 v[84:87], v[108:111], v[36:39], v[84:87]
    ds_read_b128 v[20:23], v4 offset:32768
    s_waitcnt lgkmcnt(3)
    v_mfma_f32_16x16x32_bf16 v[40:43], v[100:103], v[24:27], v[40:43]
    ds_read_b128 v[8:11], v4 offset:2048
    v_mfma_f32_16x16x32_bf16 v[44:47], v[104:107], v[24:27], v[44:47]
    v_mfma_f32_16x16x32_bf16 v[48:51], v[108:111], v[24:27], v[48:51]
    s_waitcnt lgkmcnt(3)
    v_mfma_f32_16x16x32_bf16 v[52:55], v[112:115], v[12:15], v[52:55]
    s_add_u32 m0, s79, 7168
    s_add_u32 s88, s77, 7168
    buffer_load_dwordx4 v1, s[68:71], s88 offen sc1 lds
    v_mfma_f32_16x16x32_bf16 v[56:59], v[116:119], v[12:15], v[56:59]
    s_add_u32 m0, s79, 17408
    s_add_u32 s88, s78, 7168
    buffer_load_dwordx4 v1, s[68:71], s88 offen sc1 lds
    v_mfma_f32_16x16x32_bf16 v[60:63], v[120:123], v[12:15], v[60:63]
    s_waitcnt lgkmcnt(2)
    v_mfma_f32_16x16x32_bf16 v[64:67], v[112:115], v[16:19], v[64:67]
    v_mfma_f32_16x16x32_bf16 v[68:71], v[116:119], v[16:19], v[68:71]
    v_mfma_f32_16x16x32_bf16 v[72:75], v[120:123], v[16:19], v[72:75]
    s_waitcnt vmcnt(8)
    s_barrier
    s_waitcnt lgkmcnt(1)
    v_mfma_f32_16x16x32_bf16 v[76:79], v[112:115], v[20:23], v[76:79]
    ds_read_b128 v[28:31], v4 offset:13312
    v_mfma_f32_16x16x32_bf16 v[80:83], v[116:119], v[20:23], v[80:83]
    ds_read_b128 v[32:35], v4 offset:23552
    v_mfma_f32_16x16x32_bf16 v[84:87], v[120:123], v[20:23], v[84:87]
    ds_read_b128 v[36:39], v4 offset:33792
    s_waitcnt lgkmcnt(3)
    v_mfma_f32_16x16x32_bf16 v[40:43], v[112:115], v[8:11], v[40:43]
    ds_read_b128 v[24:27], v4 offset:3072
    v_mfma_f32_16x16x32_bf16 v[44:47], v[116:119], v[8:11], v[44:47]
    v_mfma_f32_16x16x32_bf16 v[48:51], v[120:123], v[8:11], v[48:51]
    s_waitcnt lgkmcnt(3)
    v_mfma_f32_16x16x32_bf16 v[52:55], v[124:127], v[28:31], v[52:55]
    s_add_u32 m0, s79, 8192
    s_add_u32 s88, s77, 8192
    buffer_load_dwordx4 v1, s[68:71], s88 offen sc1 lds
    v_mfma_f32_16x16x32_bf16 v[56:59], v[128:131], v[28:31], v[56:59]
    s_add_u32 m0, s79, 18432
    s_add_u32 s88, s78, 8192
    buffer_load_dwordx4 v1, s[68:71], s88 offen sc1 lds
    v_mfma_f32_16x16x32_bf16 v[60:63], v[132:135], v[28:31], v[60:63]
    s_waitcnt lgkmcnt(2)
    v_mfma_f32_16x16x32_bf16 v[64:67], v[124:127], v[32:35], v[64:67]
    v_mfma_f32_16x16x32_bf16 v[68:71], v[128:131], v[32:35], v[68:71]
    v_mfma_f32_16x16x32_bf16 v[72:75], v[132:135], v[32:35], v[72:75]
    s_waitcnt vmcnt(8)
    s_barrier
    s_waitcnt lgkmcnt(1)
    v_mfma_f32_16x16x32_bf16 v[76:79], v[124:127], v[36:39], v[76:79]
    ds_read_b128 v[12:15], v4 offset:14336
    v_mfma_f32_16x16x32_bf16 v[80:83], v[128:131], v[36:39], v[80:83]
    ds_read_b128 v[16:19], v4 offset:24576
    v_mfma_f32_16x16x32_bf16 v[84:87], v[132:135], v[36:39], v[84:87]
    ds_read_b128 v[20:23], v4 offset:34816
    s_waitcnt lgkmcnt(3)
    v_mfma_f32_16x16x32_bf16 v[40:43], v[124:127], v[24:27], v[40:43]
    ds_read_b128 v[8:11], v4 offset:4096
    v_mfma_f32_16x16x32_bf16 v[44:47], v[128:131], v[24:27], v[44:47]
    v_mfma_f32_16x16x32_bf16 v[48:51], v[132:135], v[24:27], v[48:51]
    s_waitcnt lgkmcnt(3)
    v_mfma_f32_16x16x32_bf16 v[52:55], v[136:139], v[12:15], v[52:55]
    s_add_u32 m0, s79, 9216
    s_add_u32 s88, s77, 9216
    buffer_load_dwordx4 v1, s[68:71], s88 offen sc1 lds
    v_mfma_f32_16x16x32_bf16 v[56:59], v[140:143], v[12:15], v[56:59]
    s_add_u32 m0, s79, 19456
    s_add_u32 s88, s78, 9216
    buffer_load_dwordx4 v1, s[68:71], s88 offen sc1 lds
    v_mfma_f32_16x16x32_bf16 v[60:63], v[144:147], v[12:15], v[60:63]
    s_waitcnt lgkmcnt(2)
    v_mfma_f32_16x16x32_bf16 v[64:67], v[136:139], v[16:19], v[64:67]
    v_mfma_f32_16x16x32_bf16 v[68:71], v[140:143], v[16:19], v[68:71]
    v_mfma_f32_16x16x32_bf16 v[72:75], v[144:147], v[16:19], v[72:75]
    s_waitcnt vmcnt(8)
    s_barrier
    s_waitcnt lgkmcnt(1)
    v_mfma_f32_16x16x32_bf16 v[76:79], v[136:139], v[20:23], v[76:79]
    ds_read_b128 v[28:31], v4 offset:15360
    v_mfma_f32_16x16x32_bf16 v[80:83], v[140:143], v[20:23], v[80:83]
    ds_read_b128 v[32:35], v4 offset:25600
    v_mfma_f32_16x16x32_bf16 v[84:87], v[144:147], v[20:23], v[84:87]
    ds_read_b128 v[36:39], v4 offset:35840
    s_waitcnt lgkmcnt(3)
    v_mfma_f32_16x16x32_bf16 v[40:43], v[136:139], v[8:11], v[40:43]
    ds_read_b128 v[24:27], v4 offset:5120
    v_mfma_f32_16x16x32_bf16 v[44:47], v[140:143], v[8:11], v[44:47]
    v_mfma_f32_16x16x32_bf16 v[48:51], v[144:147], v[8:11], v[48:51]
    s_waitcnt lgkmcnt(3)
    v_mfma_f32_16x16x32_bf16 v[52:55], v[148:151], v[28:31], v[52:55]
    s_add_u32 m0, s79, 0
    s_add_u32 s88, s77, 10240
    buffer_load_dwordx4 v1, s[68:71], s88 offen sc1 lds
    v_mfma_f32_16x16x32_bf16 v[56:59], v[152:155], v[28:31], v[56:59]
    s_add_u32 m0, s79, 10240
    s_add_u32 s88, s78, 10240
    buffer_load_dwordx4 v1, s[68:71], s88 offen sc1 lds
    v_mfma_f32_16x16x32_bf16 v[60:63], v[156:159], v[28:31], v[60:63]
    s_waitcnt lgkmcnt(2)
    v_mfma_f32_16x16x32_bf16 v[64:67], v[148:151], v[32:35], v[64:67]
    v_mfma_f32_16x16x32_bf16 v[68:71], v[152:155], v[32:35], v[68:71]
    v_mfma_f32_16x16x32_bf16 v[72:75], v[156:159], v[32:35], v[72:75]
    s_waitcnt vmcnt(8)
    s_barrier
    s_waitcnt lgkmcnt(1)
    v_mfma_f32_16x16x32_bf16 v[76:79], v[148:151], v[36:39], v[76:79]
    ds_read_b128 v[12:15], v4 offset:16384
    v_mfma_f32_16x16x32_bf16 v[80:83], v[152:155], v[36:39], v[80:83]
    ds_read_b128 v[16:19], v4 offset:26624
    v_mfma_f32_16x16x32_bf16 v[84:87], v[156:159], v[36:39], v[84:87]
    ds_read_b128 v[20:23], v4 offset:36864
    s_waitcnt lgkmcnt(3)
    v_mfma_f32_16x16x32_bf16 v[40:43], v[148:151], v[24:27], v[40:43]
    ds_read_b128 v[8:11], v4 offset:6144
    v_mfma_f32_16x16x32_bf16 v[44:47], v[152:155], v[24:27], v[44:47]
    v_mfma_f32_16x16x32_bf16 v[48:51], v[156:159], v[24:27], v[48:51]
    s_waitcnt lgkmcnt(3)
    v_mfma_f32_16x16x32_bf16 v[52:55], v[160:163], v[12:15], v[52:55]
    s_add_u32 m0, s79, 1024
    s_add_u32 s88, s77, 11264
    buffer_load_dwordx4 v1, s[68:71], s88 offen sc1 lds
    v_mfma_f32_16x16x32_bf16 v[56:59], v[164:167], v[12:15], v[56:59]
    s_add_u32 m0, s79, 11264
    s_add_u32 s88, s78, 11264
    buffer_load_dwordx4 v1, s[68:71], s88 offen sc1 lds
    v_mfma_f32_16x16x32_bf16 v[60:63], v[168:171], v[12:15], v[60:63]
    s_waitcnt lgkmcnt(2)
    v_mfma_f32_16x16x32_bf16 v[64:67], v[160:163], v[16:19], v[64:67]
    v_mfma_f32_16x16x32_bf16 v[68:71], v[164:167], v[16:19], v[68:71]
    v_mfma_f32_16x16x32_bf16 v[72:75], v[168:171], v[16:19], v[72:75]
    s_waitcnt vmcnt(8)
    s_barrier
    s_waitcnt lgkmcnt(1)
    v_mfma_f32_16x16x32_bf16 v[76:79], v[160:163], v[20:23], v[76:79]
    ds_read_b128 v[28:31], v4 offset:17408
    v_mfma_f32_16x16x32_bf16 v[80:83], v[164:167], v[20:23], v[80:83]
    ds_read_b128 v[32:35], v4 offset:27648
    v_mfma_f32_16x16x32_bf16 v[84:87], v[168:171], v[20:23], v[84:87]
    ds_read_b128 v[36:39], v4 offset:37888
    s_waitcnt lgkmcnt(3)
    v_mfma_f32_16x16x32_bf16 v[40:43], v[160:163], v[8:11], v[40:43]
    ds_read_b128 v[24:27], v4 offset:7168
    v_mfma_f32_16x16x32_bf16 v[44:47], v[164:167], v[8:11], v[44:47]
    v_mfma_f32_16x16x32_bf16 v[48:51], v[168:171], v[8:11], v[48:51]
    s_waitcnt lgkmcnt(3)
    v_mfma_f32_16x16x32_bf16 v[52:55], v[172:175], v[28:31], v[52:55]
    s_add_u32 m0, s79, 2048
    s_add_u32 s88, s77, 12288
    buffer_load_dwordx4 v1, s[68:71], s88 offen sc1 lds
    v_mfma_f32_16x16x32_bf16 v[56:59], v[176:179], v[28:31], v[56:59]
    s_add_u32 m0, s79, 12288
    s_add_u32 s88, s78, 12288
    buffer_load_dwordx4 v1, s[68:71], s88 offen sc1 lds
    v_mfma_f32_16x16x32_bf16 v[60:63], v[180:183], v[28:31], v[60:63]
    s_waitcnt lgkmcnt(2)
    v_mfma_f32_16x16x32_bf16 v[64:67], v[172:175], v[32:35], v[64:67]
    v_mfma_f32_16x16x32_bf16 v[68:71], v[176:179], v[32:35], v[68:71]
    v_mfma_f32_16x16x32_bf16 v[72:75], v[180:183], v[32:35], v[72:75]
    s_waitcnt vmcnt(8)
    s_barrier
    s_waitcnt lgkmcnt(1)
    v_mfma_f32_16x16x32_bf16 v[76:79], v[172:175], v[36:39], v[76:79]
    ds_read_b128 v[12:15], v4 offset:18432
    v_mfma_f32_16x16x32_bf16 v[80:83], v[176:179], v[36:39], v[80:83]
    ds_read_b128 v[16:19], v4 offset:28672
    v_mfma_f32_16x16x32_bf16 v[84:87], v[180:183], v[36:39], v[84:87]
    ds_read_b128 v[20:23], v4 offset:38912
    s_waitcnt lgkmcnt(3)
    v_mfma_f32_16x16x32_bf16 v[40:43], v[172:175], v[24:27], v[40:43]
    ds_read_b128 v[8:11], v4 offset:8192
    v_mfma_f32_16x16x32_bf16 v[44:47], v[176:179], v[24:27], v[44:47]
    v_mfma_f32_16x16x32_bf16 v[48:51], v[180:183], v[24:27], v[48:51]
    s_waitcnt lgkmcnt(3)
    v_mfma_f32_16x16x32_bf16 v[52:55], v[184:187], v[12:15], v[52:55]
    s_add_u32 s88, s76, 56320
    buffer_load_dwordx4 v[220:223], v1, s[60:63], s88 offen offset:0
    v_mfma_f32_16x16x32_bf16 v[56:59], v[188:191], v[12:15], v[56:59]
    buffer_load_dwordx4 v[224:227], v1, s[60:63], s88 offen offset:1024
    v_mfma_f32_16x16x32_bf16 v[60:63], v[192:195], v[12:15], v[60:63]
    buffer_load_dwordx4 v[228:231], v1, s[60:63], s88 offen offset:2048
    s_waitcnt lgkmcnt(2)
    v_mfma_f32_16x16x32_bf16 v[64:67], v[184:187], v[16:19], v[64:67]
    s_add_u32 m0, s79, 3072
    s_add_u32 s88, s77, 13312
    buffer_load_dwordx4 v1, s[72:75], s88 offen sc1 lds
    v_mfma_f32_16x16x32_bf16 v[68:71], v[188:191], v[16:19], v[68:71]
    s_add_u32 m0, s79, 13312
    s_add_u32 s88, s78, 13312
    buffer_load_dwordx4 v1, s[72:75], s88 offen sc1 lds
    v_mfma_f32_16x16x32_bf16 v[72:75], v[192:195], v[16:19], v[72:75]
    s_waitcnt vmcnt(11)
    s_barrier
    s_waitcnt lgkmcnt(1)
    v_mfma_f32_16x16x32_bf16 v[76:79], v[184:187], v[20:23], v[76:79]
    ds_read_b128 v[28:31], v4 offset:19456
    v_mfma_f32_16x16x32_bf16 v[80:83], v[188:191], v[20:23], v[80:83]
    ds_read_b128 v[32:35], v4 offset:29696
    v_mfma_f32_16x16x32_bf16 v[84:87], v[192:195], v[20:23], v[84:87]
    ds_read_b128 v[36:39], v4 offset:39936
    s_waitcnt lgkmcnt(3)
    v_mfma_f32_16x16x32_bf16 v[40:43], v[184:187], v[8:11], v[40:43]
    ds_read_b128 v[24:27], v4 offset:9216
    v_mfma_f32_16x16x32_bf16 v[44:47], v[188:191], v[8:11], v[44:47]
    v_mfma_f32_16x16x32_bf16 v[48:51], v[192:195], v[8:11], v[48:51]
    s_waitcnt lgkmcnt(3)
    v_mfma_f32_16x16x32_bf16 v[52:55], v[196:199], v[28:31], v[52:55]
    s_add_u32 s88, s76, 61440
    buffer_load_dwordx4 v[232:235], v1, s[60:63], s88 offen offset:0
    v_mfma_f32_16x16x32_bf16 v[56:59], v[200:203], v[28:31], v[56:59]
    buffer_load_dwordx4 v[236:239], v1, s[60:63], s88 offen offset:1024
    v_mfma_f32_16x16x32_bf16 v[60:63], v[204:207], v[28:31], v[60:63]
    buffer_load_dwordx4 v[240:243], v1, s[60:63], s88 offen offset:2048
    s_waitcnt lgkmcnt(2)
    v_mfma_f32_16x16x32_bf16 v[64:67], v[196:199], v[32:35], v[64:67]
    v_mfma_f32_16x16x32_bf16 v[68:71], v[200:203], v[32:35], v[68:71]
    v_mfma_f32_16x16x32_bf16 v[72:75], v[204:207], v[32:35], v[72:75]
    s_waitcnt vmcnt(12)
    s_barrier
    s_waitcnt lgkmcnt(1)
    v_mfma_f32_16x16x32_bf16 v[76:79], v[196:199], v[36:39], v[76:79]
    ds_read_b128 v[12:15], v4 offset:10240
    v_mfma_f32_16x16x32_bf16 v[80:83], v[200:203], v[36:39], v[80:83]
    ds_read_b128 v[16:19], v4 offset:20480
    v_mfma_f32_16x16x32_bf16 v[84:87], v[204:207], v[36:39], v[84:87]
    ds_read_b128 v[20:23], v4 offset:30720
    s_waitcnt lgkmcnt(3)
    v_mfma_f32_16x16x32_bf16 v[40:43], v[196:199], v[24:27], v[40:43]
    ds_read_b128 v[8:11], v4 offset:0
    v_mfma_f32_16x16x32_bf16 v[44:47], v[200:203], v[24:27], v[44:47]
    v_mfma_f32_16x16x32_bf16 v[48:51], v[204:207], v[24:27], v[48:51]
    s_waitcnt lgkmcnt(3)
    v_mfma_f32_16x16x32_bf16 v[52:55], v[208:211], v[12:15], v[52:55]
    s_add_u32 s88, s76, 66560
    buffer_load_dwordx4 v[244:247], v1, s[64:67], s88 offen offset:0
    v_mfma_f32_16x16x32_bf16 v[56:59], v[212:215], v[12:15], v[56:59]
    buffer_load_dwordx4 v[248:251], v1, s[64:67], s88 offen offset:1024
    v_mfma_f32_16x16x32_bf16 v[60:63], v[216:219], v[12:15], v[60:63]
    buffer_load_dwordx4 v[252:255], v1, s[64:67], s88 offen offset:2048
    s_waitcnt lgkmcnt(2)
    v_mfma_f32_16x16x32_bf16 v[64:67], v[208:211], v[16:19], v[64:67]
    v_mfma_f32_16x16x32_bf16 v[68:71], v[212:215], v[16:19], v[68:71]
    v_mfma_f32_16x16x32_bf16 v[72:75], v[216:219], v[16:19], v[72:75]
    s_waitcnt vmcnt(13)
    s_barrier
    s_waitcnt lgkmcnt(1)
    v_mfma_f32_16x16x32_bf16 v[76:79], v[208:211], v[20:23], v[76:79]
    ds_read_b128 v[28:31], v4 offset:11264
    v_mfma_f32_16x16x32_bf16 v[80:83], v[212:215], v[20:23], v[80:83]
    ds_read_b128 v[32:35], v4 offset:21504
    v_mfma_f32_16x16x32_bf16 v[84:87], v[216:219], v[20:23], v[84:87]
    ds_read_b128 v[36:39], v4 offset:31744
    s_waitcnt lgkmcnt(3)
    v_mfma_f32_16x16x32_bf16 v[40:43], v[208:211], v[8:11], v[40:43]
    ds_read_b128 v[24:27], v4 offset:1024
    v_mfma_f32_16x16x32_bf16 v[44:47], v[212:215], v[8:11], v[44:47]
    v_mfma_f32_16x16x32_bf16 v[48:51], v[216:219], v[8:11], v[48:51]
    s_waitcnt vmcnt(8)
    s_waitcnt lgkmcnt(3)
    v_mfma_f32_16x16x32_bf16 v[52:55], v[220:223], v[28:31], v[52:55]
    buffer_load_dwordx4 v[88:91], v3, s[32:35], s23 offen offset:0
    v_mfma_f32_16x16x32_bf16 v[56:59], v[224:227], v[28:31], v[56:59]
    buffer_load_dwordx4 v[92:95], v3, s[32:35], s23 offen offset:64
    v_mfma_f32_16x16x32_bf16 v[60:63], v[228:231], v[28:31], v[60:63]
    buffer_load_dwordx4 v[96:99], v3, s[32:35], s23 offen offset:128
    s_waitcnt lgkmcnt(2)
    v_mfma_f32_16x16x32_bf16 v[64:67], v[220:223], v[32:35], v[64:67]
    s_add_u32 m0, s26, 34816
    s_add_u32 s88, s22, 0
    buffer_load_dwordx4 v2, s[28:31], s88 offen lds
    v_mfma_f32_16x16x32_bf16 v[68:71], v[224:227], v[32:35], v[68:71]
    v_mfma_f32_16x16x32_bf16 v[72:75], v[228:231], v[32:35], v[72:75]
    s_waitcnt vmcnt(15)
    s_barrier
    s_waitcnt lgkmcnt(1)
    v_mfma_f32_16x16x32_bf16 v[76:79], v[220:223], v[36:39], v[76:79]
    ds_read_b128 v[12:15], v4 offset:12288
    v_mfma_f32_16x16x32_bf16 v[80:83], v[224:227], v[36:39], v[80:83]
    ds_read_b128 v[16:19], v4 offset:22528
    v_mfma_f32_16x16x32_bf16 v[84:87], v[228:231], v[36:39], v[84:87]
    ds_read_b128 v[20:23], v4 offset:32768
    s_waitcnt lgkmcnt(3)
    v_mfma_f32_16x16x32_bf16 v[40:43], v[220:223], v[24:27], v[40:43]
    ds_read_b128 v[8:11], v4 offset:2048
    v_mfma_f32_16x16x32_bf16 v[44:47], v[224:227], v[24:27], v[44:47]
    v_mfma_f32_16x16x32_bf16 v[48:51], v[228:231], v[24:27], v[48:51]
    s_waitcnt vmcnt(7)
    s_waitcnt lgkmcnt(3)
    v_mfma_f32_16x16x32_bf16 v[52:55], v[232:235], v[12:15], v[52:55]
    s_add_u32 m0, s26, 35840
    s_add_u32 s88, s22, 139264
    buffer_load_dwordx4 v2, s[28:31], s88 offen lds
    v_mfma_f32_16x16x32_bf16 v[56:59], v[236:239], v[12:15], v[56:59]
    v_mfma_f32_16x16x32_bf16 v[60:63], v[240:243], v[12:15], v[60:63]
    s_waitcnt lgkmcnt(2)
    v_mfma_f32_16x16x32_bf16 v[64:67], v[232:235], v[16:19], v[64:67]
    v_mfma_f32_16x16x32_bf16 v[68:71], v[236:239], v[16:19], v[68:71]
    v_mfma_f32_16x16x32_bf16 v[72:75], v[240:243], v[16:19], v[72:75]
    s_waitcnt vmcnt(11)
    s_barrier
    s_waitcnt lgkmcnt(1)
    v_mfma_f32_16x16x32_bf16 v[76:79], v[232:235], v[20:23], v[76:79]
    ds_read_b128 v[28:31], v4 offset:13312
    v_mfma_f32_16x16x32_bf16 v[80:83], v[236:239], v[20:23], v[80:83]
    ds_read_b128 v[32:35], v4 offset:23552
    v_mfma_f32_16x16x32_bf16 v[84:87], v[240:243], v[20:23], v[84:87]
    ds_read_b128 v[36:39], v4 offset:33792
    s_waitcnt lgkmcnt(3)
    v_mfma_f32_16x16x32_bf16 v[40:43], v[232:235], v[8:11], v[40:43]
    ds_read_b128 v[24:27], v4 offset:3072
    v_mfma_f32_16x16x32_bf16 v[44:47], v[236:239], v[8:11], v[44:47]
    v_mfma_f32_16x16x32_bf16 v[48:51], v[240:243], v[8:11], v[48:51]
    s_waitcnt vmcnt(5)
    s_nop 3
    s_add_u32 s88, s54, 1
    s_and_b32 s88, s88, 3
    s_mul_i32 s88, s88, 40960
    v_add_u32 v13, s88, v1
    s_add_u32 s88, s54, 2
    s_and_b32 s88, s88, 3
    s_mul_i32 s88, s88, 40960
    v_add_u32 v14, s88, v1
    s_add_u32 s88, s54, 3
    s_and_b32 s88, s88, 3
    s_mul_i32 s88, s88, 40960
    v_add_u32 v15, s88, v1
    s_cmp_ge_u32 s54, 2
    s_cbranch_scc1 p2_skip3
    s_waitcnt lgkmcnt(3)
    v_mfma_f32_16x16x32_bf16 v[52:55], v[244:247], v[28:31], v[52:55]
    v_mfma_f32_16x16x32_bf16 v[56:59], v[248:251], v[28:31], v[56:59]
    v_mfma_f32_16x16x32_bf16 v[60:63], v[252:255], v[28:31], v[60:63]
    s_waitcnt lgkmcnt(2)
    v_mfma_f32_16x16x32_bf16 v[64:67], v[244:247], v[32:35], v[64:67]
    v_mfma_f32_16x16x32_bf16 v[68:71], v[248:251], v[32:35], v[68:71]
    v_mfma_f32_16x16x32_bf16 v[72:75], v[252:255], v[32:35], v[72:75]
    s_waitcnt lgkmcnt(1)
    v_mfma_f32_16x16x32_bf16 v[76:79], v[244:247], v[36:39], v[76:79]
    v_mfma_f32_16x16x32_bf16 v[80:83], v[248:251], v[36:39], v[80:83]
    v_mfma_f32_16x16x32_bf16 v[84:87], v[252:255], v[36:39], v[84:87]
    ds_write_b128 v13, v[52:55] offset:4096
    ds_write_b128 v13, v[56:59] offset:5120
    ds_write_b128 v13, v[60:63] offset:6144
    s_waitcnt lgkmcnt(3)
    v_mfma_f32_16x16x32_bf16 v[40:43], v[244:247], v[24:27], v[40:43]
    v_mfma_f32_16x16x32_bf16 v[44:47], v[248:251], v[24:27], v[44:47]
    v_mfma_f32_16x16x32_bf16 v[48:51], v[252:255], v[24:27], v[48:51]
    ds_write_b128 v14, v[64:67] offset:14336
    ds_write_b128 v14, v[68:71] offset:15360
    ds_write_b128 v14, v[72:75] offset:16384
    s_branch p2_w3
p2_skip3:
    ds_write_b128 v13, v[52:55] offset:4096
    ds_write_b128 v13, v[56:59] offset:5120
    ds_write_b128 v13, v[60:63] offset:6144
    ds_write_b128 v14, v[64:67] offset:14336
    ds_write_b128 v14, v[68:71] offset:15360
    ds_write_b128 v14, v[72:75] offset:16384
p2_w3:
    s_nop 3
    ds_write_b128 v15, v[76:79] offset:24576
    ds_write_b128 v15, v[80:83] offset:25600
    ds_write_b128 v15, v[84:87] offset:26624
    s_mov_b32 s43, 0xffff0000
    s_waitcnt vmcnt(0)
    ds_read_b64_tr_b16 v[100:101], v5 offset:34816
    ds_read_b64_tr_b16 v[104:105], v5 offset:35328
    ds_read_b64_tr_b16 v[108:109], v5 offset:35840
    s_waitcnt lgkmcnt(0)
    s_barrier
    ds_read_b128 v[52:55], v4 offset:4096
    ds_read_b128 v[64:67], v4 offset:14336
    ds_read_b128 v[76:79], v4 offset:24576
    ds_read_b128 v[56:59], v4 offset:5120
    ds_read_b128 v[68:71], v4 offset:15360
    ds_read_b128 v[80:83], v4 offset:25600
    ds_read_b128 v[60:63], v4 offset:6144
    ds_read_b128 v[72:75], v4 offset:16384
    ds_read_b128 v[84:87], v4 offset:26624
    s_waitcnt vmcnt(0)
    v_and_b32 v103, s43, v101
    v_lshlrev_b32 v102, 16, v101
    v_and_b32 v101, s43, v100
    v_lshlrev_b32 v100, 16, v100
    v_and_b32 v107, s43, v105
    v_lshlrev_b32 v106, 16, v105
    v_and_b32 v105, s43, v104
    v_lshlrev_b32 v104, 16, v104
    v_and_b32 v111, s43, v109
    v_lshlrev_b32 v110, 16, v109
    v_and_b32 v109, s43, v108
    v_lshlrev_b32 v108, 16, v108
    s_waitcnt lgkmcnt(6)
    v_pk_add_f32 v[40:41], v[40:41], v[52:53]
    v_pk_add_f32 v[42:43], v[42:43], v[54:55]
    v_pk_add_f32 v[64:65], v[64:65], v[76:77]
    v_pk_add_f32 v[66:67], v[66:67], v[78:79]
    v_pk_add_f32 v[40:41], v[40:41], v[64:65]
    v_pk_add_f32 v[42:43], v[42:43], v[66:67]
    v_cvt_pk_bf16_f32 v40, v40, v41
    v_cvt_pk_bf16_f32 v42, v42, v43
    v_and_b32 v41, s43, v40
    v_and_b32 v43, s43, v42
    v_lshlrev_b32 v40, 16, v40
    v_lshlrev_b32 v42, 16, v42
    v_pk_mul_f32 v[40:41], v[40:41], v[88:89]
    v_pk_mul_f32 v[42:43], v[42:43], v[90:91]
    v_cvt_pk_bf16_f32 v40, v40, v41
    v_cvt_pk_bf16_f32 v42, v42, v43
    v_and_b32 v41, s43, v40
    v_and_b32 v43, s43, v42
    v_lshlrev_b32 v40, 16, v40
    v_lshlrev_b32 v42, 16, v42
    v_pk_add_f32 v[40:41], v[40:41], v[100:101]
    v_pk_add_f32 v[42:43], v[42:43], v[102:103]
    v_cvt_pk_bf16_f32 v8, v40, v41
    v_cvt_pk_bf16_f32 v9, v42, v43
    s_waitcnt lgkmcnt(3)
    v_pk_add_f32 v[44:45], v[44:45], v[56:57]
    v_pk_add_f32 v[46:47], v[46:47], v[58:59]
    v_pk_add_f32 v[68:69], v[68:69], v[80:81]
    v_pk_add_f32 v[70:71], v[70:71], v[82:83]
    v_pk_add_f32 v[44:45], v[44:45], v[68:69]
    v_pk_add_f32 v[46:47], v[46:47], v[70:71]
    v_cvt_pk_bf16_f32 v44, v44, v45
    v_cvt_pk_bf16_f32 v46, v46, v47
    v_and_b32 v45, s43, v44
    v_and_b32 v47, s43, v46
    v_lshlrev_b32 v44, 16, v44
    v_lshlrev_b32 v46, 16, v46
    v_pk_mul_f32 v[44:45], v[44:45], v[92:93]
    v_pk_mul_f32 v[46:47], v[46:47], v[94:95]
    v_cvt_pk_bf16_f32 v44, v44, v45
    v_cvt_pk_bf16_f32 v46, v46, v47
    v_and_b32 v45, s43, v44
    v_and_b32 v47, s43, v46
    v_lshlrev_b32 v44, 16, v44
    v_lshlrev_b32 v46, 16, v46
    v_pk_add_f32 v[44:45], v[44:45], v[104:105]
    v_pk_add_f32 v[46:47], v[46:47], v[106:107]
    v_cvt_pk_bf16_f32 v10, v44, v45
    v_cvt_pk_bf16_f32 v11, v46, v47
    s_nop 1
    v_permlane32_swap_b32 v8, v10
    v_permlane32_swap_b32 v9, v11
    s_nop 1
    v_permlane16_swap_b32 v8, v10
    v_permlane16_swap_b32 v9, v11
    s_nop 1
    buffer_store_dwordx4 v[8:11], v6, s[36:39], s24 offen
    s_waitcnt lgkmcnt(0)
    v_pk_add_f32 v[48:49], v[48:49], v[60:61]
    v_pk_add_f32 v[50:51], v[50:51], v[62:63]
    v_pk_add_f32 v[72:73], v[72:73], v[84:85]
    v_pk_add_f32 v[74:75], v[74:75], v[86:87]
    v_pk_add_f32 v[48:49], v[48:49], v[72:73]
    v_pk_add_f32 v[50:51], v[50:51], v[74:75]
    v_cvt_pk_bf16_f32 v48, v48, v49
    v_cvt_pk_bf16_f32 v50, v50, v51
    v_and_b32 v49, s43, v48
    v_and_b32 v51, s43, v50
    v_lshlrev_b32 v48, 16, v48
    v_lshlrev_b32 v50, 16, v50
    v_pk_mul_f32 v[48:49], v[48:49], v[96:97]
    v_pk_mul_f32 v[50:51], v[50:51], v[98:99]
    v_cvt_pk_bf16_f32 v48, v48, v49
    v_cvt_pk_bf16_f32 v50, v50, v51
    v_and_b32 v49, s43, v48
    v_and_b32 v51, s43, v50
    v_lshlrev_b32 v48, 16, v48
    v_lshlrev_b32 v50, 16, v50
    v_pk_add_f32 v[48:49], v[48:49], v[108:109]
    v_pk_add_f32 v[50:51], v[50:51], v[110:111]
    v_cvt_pk_bf16_f32 v12, v48, v49
    v_cvt_pk_bf16_f32 v13, v50, v51
    buffer_store_dwordx2 v[12:13], v7, s[36:39], s24 offen offset:64
    s_endpgm
g1_compute:
    s_add_u32 s36, s14, 13828096
    s_addc_u32 s37, s15, 0
    s_mov_b32 s38, 7077888
    s_mov_b32 s39, 0x00020000
    s_cmp_lt_u32 s25, 54
    s_cselect_b32 s38, s38, 0
    s_mul_i32 s29, s20, 432
    s_add_u32 s29, s29, s25
    s_lshl_b32 s29, s29, 10
    s_lshl_b32 s31, s26, 1
    v_lshrrev_b32 v5, 2, v1
    v_and_b32 v6, 7, v5
    v_and_b32 v7, 3, v1
    v_lshlrev_b32 v7, 3, v7
    v_lshl_add_u32 v5, v5, 8, v7
    s_add_u32 s30, s31, 0
    s_and_b32 s30, s30, 7
    v_xor_b32 v7, s30, v6
    v_lshl_add_u32 v8, v7, 5, v5
    s_mul_i32 s30, s30, 55296
    s_add_u32 s3, s30, s29
    s_add_u32 s30, s31, 1
    s_and_b32 s30, s30, 7
    v_xor_b32 v7, s30, v6
    v_lshl_add_u32 v9, v7, 5, v5
    s_mul_i32 s30, s30, 55296
    s_add_u32 s4, s30, s29
    s_add_u32 s30, s31, 2
    s_and_b32 s30, s30, 7
    v_xor_b32 v7, s30, v6
    v_lshl_add_u32 v10, v7, 5, v5
    s_mul_i32 s30, s30, 55296
    s_add_u32 s5, s30, s29
    s_add_u32 s30, s31, 3
    s_and_b32 s30, s30, 7
    v_xor_b32 v7, s30, v6
    v_lshl_add_u32 v11, v7, 5, v5
    s_mul_i32 s30, s30, 55296
    s_add_u32 s6, s30, s29
    s_add_u32 s30, s31, 4
    s_and_b32 s30, s30, 7
    v_xor_b32 v7, s30, v6
    v_lshl_add_u32 v12, v7, 5, v5
    s_mul_i32 s30, s30, 55296
    s_add_u32 s7, s30, s29
    s_add_u32 s30, s31, 5
    s_and_b32 s30, s30, 7
    v_xor_b32 v7, s30, v6
    v_lshl_add_u32 v13, v7, 5, v5
    s_mul_i32 s30, s30, 55296
    s_add_u32 s8, s30, s29
    s_add_u32 s30, s31, 6
    s_and_b32 s30, s30, 7
    v_xor_b32 v7, s30, v6
    v_lshl_add_u32 v14, v7, 5, v5
    s_mul_i32 s30, s30, 55296
    s_add_u32 s9, s30, s29
    s_add_u32 s30, s31, 7
    s_and_b32 s30, s30, 7
    v_xor_b32 v7, s30, v6
    v_lshl_add_u32 v15, v7, 5, v5
    s_mul_i32 s30, s30, 55296
    s_add_u32 s12, s30, s29
    v_lshrrev_b32 v5, 1, v3
    v_lshlrev_b32 v5, 12, v5
    v_lshl_add_u32 v17, v4, 4, v5
    v_lshl_add_u32 v17, v2, 9, v17
    v_add_u32 v17, 131072, v17
    v_and_b32 v5, 1, v3
    v_lshl_add_u32 v18, v5, 8, v17
    s_cmp_eq_u32 s26, 3
    s_cselect_b32 s30, 0, 2048
    v_add_u32 v19, s30, v18
    v_mov_b32 v27, 1.0
    v_cmp_eq_u32 s[48:49], 1, v5
    v_and_b32 v6, 3, v4
    v_cmp_eq_u32 s[40:41], 1, v6
    v_cmp_eq_u32 s[42:43], 2, v6
    v_cmp_eq_u32 s[46:47], 3, v6
    v_lshrrev_b32 v6, 2, v4
    v_cmp_eq_u32 s[50:51], v6, v3
    v_cmp_lt_u32 s[44:45], 31, v1
    s_mov_b32 s23, 0xffff0000
    v_mov_b32 v20, 0x3f803f80
    v_mov_b32 v21, 0x3f803f80
    v_mov_b32 v22, 0x3f803f80
    v_mov_b32 v23, 0x3f803f80
    v_mov_b32 v96, 0
    v_mov_b32 v97, 0
    v_mov_b32 v98, 0
    v_mov_b32 v99, 0
    v_mov_b32 v100, 0
    v_mov_b32 v101, 0
    v_mov_b32 v102, 0
    v_mov_b32 v103, 0
    v_mov_b32 v104, 0
    v_mov_b32 v105, 0
    v_mov_b32 v106, 0
    v_mov_b32 v107, 0
    v_mov_b32 v108, 0
    v_mov_b32 v109, 0
    v_mov_b32 v110, 0
    v_mov_b32 v111, 0
    v_mov_b32 v112, 0
    v_mov_b32 v113, 0
    v_mov_b32 v114, 0
    v_mov_b32 v115, 0
    v_mov_b32 v116, 0
    v_mov_b32 v117, 0
    v_mov_b32 v118, 0
    v_mov_b32 v119, 0
    v_mov_b32 v120, 0
    v_mov_b32 v121, 0
    v_mov_b32 v122, 0
    v_mov_b32 v123, 0
    v_mov_b32 v124, 0
    v_mov_b32 v125, 0
    v_mov_b32 v126, 0
    v_mov_b32 v127, 0
    v_mov_b32 v128, 0
    v_mov_b32 v129, 0
    v_mov_b32 v130, 0
    v_mov_b32 v131, 0
    v_mov_b32 v132, 0
    v_mov_b32 v133, 0
    v_mov_b32 v134, 0
    v_mov_b32 v135, 0
    v_mov_b32 v136, 0
    v_mov_b32 v137, 0
    v_mov_b32 v138, 0
    v_mov_b32 v139, 0
    v_mov_b32 v140, 0
    v_mov_b32 v141, 0
    v_mov_b32 v142, 0
    v_mov_b32 v143, 0
    v_mov_b32 v144, 0
    v_mov_b32 v145, 0
    v_mov_b32 v146, 0
    v_mov_b32 v147, 0
    v_mov_b32 v148, 0
    v_mov_b32 v149, 0
    v_mov_b32 v150, 0
    v_mov_b32 v151, 0
    v_mov_b32 v152, 0
    v_mov_b32 v153, 0
    v_mov_b32 v154, 0
    v_mov_b32 v155, 0
    v_mov_b32 v156, 0
    v_mov_b32 v157, 0
    v_mov_b32 v158, 0
    v_mov_b32 v159, 0
    v_mov_b32 v240, 0
    v_mov_b32 v241, 0
    v_mov_b32 v242, 0
    v_mov_b32 v243, 0
    v_mov_b32 v244, 0
    v_mov_b32 v245, 0
    v_mov_b32 v246, 0
    v_mov_b32 v247, 0
    v_mov_b32 v248, 0
    v_mov_b32 v249, 0
    v_mov_b32 v250, 0
    v_mov_b32 v251, 0
    v_mov_b32 v252, 0
    v_mov_b32 v253, 0
    v_mov_b32 v254, 0
    v_mov_b32 v255, 0
    s_load_dwordx2 s[10:11], s[0:1], 112
    s_and_b32 s54, s26, 3
    s_lshr_b32 s55, s26, 2
    s_add_u32 s60, s14, 21348352
    s_addc_u32 s61, s15, 0
    s_mov_b32 s62, 2211840
    s_mov_b32 s63, 0x00020000
    s_add_u32 s64, s14, 21348352
    s_addc_u32 s65, s15, 0
    s_mov_b32 s66, 2211840
    s_mov_b32 s67, 0x00020000
    s_add_u32 s68, s14, 13828096
    s_addc_u32 s69, s15, 0
    s_mov_b32 s70, 7077888
    s_mov_b32 s71, 0x00020000
    s_add_u32 s72, s14, 13828096
    s_addc_u32 s73, s15, 0
    s_mov_b32 s74, 7077888
    s_mov_b32 s75, 0x00020000
    s_cmp_lt_u32 s54, 2
    s_cselect_b32 s66, s66, 0
    s_cselect_b32 s74, s74, 0
    s_mul_i32 s88, s54, 14
    s_cmp_eq_u32 s54, 3
    s_subb_u32 s88, s88, 0
    s_mul_i32 s76, s53, 54
    s_add_u32 s76, s76, s88
    s_mul_i32 s76, s76, 5120
    s_lshl_b32 s89, s55, 1
    s_add_u32 s89, s89, s54
    s_and_b32 s89, s89, 3
    s_lshl_b32 s90, s52, 2
    s_add_u32 s89, s89, s90
    s_mul_i32 s89, s89, 54
    s_add_u32 s89, s89, s88
    s_lshl_b32 s77, s89, 10
    s_lshl_b32 s89, s55, 1
    s_add_u32 s89, s89, s54
    s_add_u32 s89, s89, 1
    s_and_b32 s89, s89, 3
    s_lshl_b32 s90, s52, 2
    s_add_u32 s89, s89, s90
    s_mul_i32 s89, s89, 54
    s_add_u32 s89, s89, s88
    s_lshl_b32 s78, s89, 10
    s_lshl_b32 s79, s54, 1
    s_add_u32 s79, s79, s55
    s_mul_i32 s79, s79, 20480
    s_add_u32 s80, s14, 11042816
    s_addc_u32 s81, s15, 0
    s_mov_b32 s82, 65536
    s_mov_b32 s83, 0x00020000
    s_load_dwordx2 s[56:57], s[14:15], 32768
    v_mov_b32 v92, v12
    v_lshlrev_b32 v12, 4, v0
    v_mov_b32 v28, 0
    v_mov_b32 v29, 0
    v_mov_b32 v30, 0
    v_mov_b32 v31, 0
    v_add_u32 v12, 131072, v12
    ds_write_b128 v12, v[28:31]
    s_waitcnt lgkmcnt(0)
    v_mov_b32 v12, v92
    s_barrier
    ds_read_b64_tr_b16 v[32:33], v8 offset:0
    ds_read_b64_tr_b16 v[34:35], v8 offset:4096
    ds_read_b64_tr_b16 v[36:37], v9 offset:0
    ds_read_b64_tr_b16 v[38:39], v9 offset:4096
    ds_read_b64_tr_b16 v[40:41], v10 offset:0
    ds_read_b64_tr_b16 v[42:43], v10 offset:4096
    ds_read_b64_tr_b16 v[44:45], v11 offset:0
    ds_read_b64_tr_b16 v[46:47], v11 offset:4096
    ds_read_b64_tr_b16 v[48:49], v12 offset:0
    ds_read_b64_tr_b16 v[50:51], v12 offset:4096
    ds_read_b64_tr_b16 v[52:53], v13 offset:0
    ds_read_b64_tr_b16 v[54:55], v13 offset:4096
    ds_read_b64_tr_b16 v[56:57], v14 offset:0
    ds_read_b64_tr_b16 v[58:59], v14 offset:4096
    ds_read_b64_tr_b16 v[60:61], v15 offset:0
    ds_read_b64_tr_b16 v[62:63], v15 offset:4096
    s_waitcnt lgkmcnt(14)
    v_mfma_f32_16x16x32_bf16 v[248:251], v[32:35], v[32:35], v[248:251]
    ds_read_b64_tr_b16 v[64:65], v8 offset:8192
    v_mfma_f32_16x16x32_bf16 v[240:243], v[20:23], v[32:35], v[240:243]
    ds_read_b64_tr_b16 v[66:67], v8 offset:12288
    s_waitcnt lgkmcnt(14)
    v_mfma_f32_16x16x32_bf16 v[252:255], v[36:39], v[36:39], v[252:255]
    ds_read_b64_tr_b16 v[68:69], v9 offset:8192
    v_mfma_f32_16x16x32_bf16 v[244:247], v[20:23], v[36:39], v[244:247]
    ds_read_b64_tr_b16 v[70:71], v9 offset:12288
    s_waitcnt vmcnt(6)
    v_mfma_f32_16x16x32_bf16 v[96:99], v[160:163], v[32:35], v[96:99]
    ds_read_b64_tr_b16 v[72:73], v10 offset:8192
    v_mfma_f32_16x16x32_bf16 v[100:103], v[164:167], v[32:35], v[100:103]
    ds_read_b64_tr_b16 v[74:75], v10 offset:12288
    v_mfma_f32_16x16x32_bf16 v[104:107], v[160:163], v[36:39], v[104:107]
    ds_read_b64_tr_b16 v[76:77], v11 offset:8192
    v_mfma_f32_16x16x32_bf16 v[108:111], v[164:167], v[36:39], v[108:111]
    ds_read_b64_tr_b16 v[78:79], v11 offset:12288
    s_waitcnt lgkmcnt(15)
    v_mfma_f32_16x16x32_bf16 v[112:115], v[160:163], v[40:43], v[112:115]
    ds_read_b64_tr_b16 v[80:81], v12 offset:8192
    v_mfma_f32_16x16x32_bf16 v[116:119], v[164:167], v[40:43], v[116:119]
    ds_read_b64_tr_b16 v[82:83], v12 offset:12288
    v_mfma_f32_16x16x32_bf16 v[120:123], v[160:163], v[44:47], v[120:123]
    ds_read_b64_tr_b16 v[84:85], v13 offset:8192
    v_mfma_f32_16x16x32_bf16 v[124:127], v[164:167], v[44:47], v[124:127]
    ds_read_b64_tr_b16 v[86:87], v13 offset:12288
    s_waitcnt lgkmcnt(15)
    v_mfma_f32_16x16x32_bf16 v[128:131], v[160:163], v[48:51], v[128:131]
    ds_read_b64_tr_b16 v[88:89], v14 offset:8192
    v_mfma_f32_16x16x32_bf16 v[132:135], v[164:167], v[48:51], v[132:135]
    ds_read_b64_tr_b16 v[90:91], v14 offset:12288
    v_mfma_f32_16x16x32_bf16 v[136:139], v[160:163], v[52:55], v[136:139]
    ds_read_b64_tr_b16 v[92:93], v15 offset:8192
    v_mfma_f32_16x16x32_bf16 v[140:143], v[164:167], v[52:55], v[140:143]
    ds_read_b64_tr_b16 v[94:95], v15 offset:12288
    s_add_u32 s28, s27, 8192
    buffer_load_dwordx4 v[192:195], v16, s[32:35], s28 offen offset:0
    s_waitcnt lgkmcnt(15)
    v_mfma_f32_16x16x32_bf16 v[144:147], v[160:163], v[56:59], v[144:147]
    buffer_load_dwordx4 v[196:199], v16, s[32:35], s28 offen offset:1024
    v_mfma_f32_16x16x32_bf16 v[148:151], v[164:167], v[56:59], v[148:151]
    v_mfma_f32_16x16x32_bf16 v[152:155], v[160:163], v[60:63], v[152:155]
    v_mfma_f32_16x16x32_bf16 v[156:159], v[164:167], v[60:63], v[156:159]
    s_barrier
    s_waitcnt lgkmcnt(14)
    v_mfma_f32_16x16x32_bf16 v[248:251], v[64:67], v[64:67], v[248:251]
    ds_read_b64_tr_b16 v[32:33], v8 offset:16384
    v_mfma_f32_16x16x32_bf16 v[240:243], v[20:23], v[64:67], v[240:243]
    ds_read_b64_tr_b16 v[34:35], v8 offset:20480
    s_waitcnt lgkmcnt(14)
    v_mfma_f32_16x16x32_bf16 v[252:255], v[68:71], v[68:71], v[252:255]
    ds_read_b64_tr_b16 v[36:37], v9 offset:16384
    v_mfma_f32_16x16x32_bf16 v[244:247], v[20:23], v[68:71], v[244:247]
    ds_read_b64_tr_b16 v[38:39], v9 offset:20480
    s_waitcnt vmcnt(6)
    v_mfma_f32_16x16x32_bf16 v[96:99], v[168:171], v[64:67], v[96:99]
    ds_read_b64_tr_b16 v[40:41], v10 offset:16384
    v_mfma_f32_16x16x32_bf16 v[100:103], v[172:175], v[64:67], v[100:103]
    ds_read_b64_tr_b16 v[42:43], v10 offset:20480
    v_mfma_f32_16x16x32_bf16 v[104:107], v[168:171], v[68:71], v[104:107]
    ds_read_b64_tr_b16 v[44:45], v11 offset:16384
    v_mfma_f32_16x16x32_bf16 v[108:111], v[172:175], v[68:71], v[108:111]
    ds_read_b64_tr_b16 v[46:47], v11 offset:20480
    s_waitcnt lgkmcnt(15)
    v_mfma_f32_16x16x32_bf16 v[112:115], v[168:171], v[72:75], v[112:115]
    ds_read_b64_tr_b16 v[48:49], v12 offset:16384
    v_mfma_f32_16x16x32_bf16 v[116:119], v[172:175], v[72:75], v[116:119]
    ds_read_b64_tr_b16 v[50:51], v12 offset:20480
    v_mfma_f32_16x16x32_bf16 v[120:123], v[168:171], v[76:79], v[120:123]
    ds_read_b64_tr_b16 v[52:53], v13 offset:16384
    v_mfma_f32_16x16x32_bf16 v[124:127], v[172:175], v[76:79], v[124:127]
    ds_read_b64_tr_b16 v[54:55], v13 offset:20480
    s_waitcnt lgkmcnt(15)
    v_mfma_f32_16x16x32_bf16 v[128:131], v[168:171], v[80:83], v[128:131]
    ds_read_b64_tr_b16 v[56:57], v14 offset:16384
    v_mfma_f32_16x16x32_bf16 v[132:135], v[172:175], v[80:83], v[132:135]
    ds_read_b64_tr_b16 v[58:59], v14 offset:20480
    v_mfma_f32_16x16x32_bf16 v[136:139], v[168:171], v[84:87], v[136:139]
    ds_read_b64_tr_b16 v[60:61], v15 offset:16384
    v_mfma_f32_16x16x32_bf16 v[140:143], v[172:175], v[84:87], v[140:143]
    ds_read_b64_tr_b16 v[62:63], v15 offset:20480
    s_add_u32 s28, s27, 10240
    buffer_load_dwordx4 v[200:203], v16, s[32:35], s28 offen offset:0
    s_waitcnt lgkmcnt(15)
    v_mfma_f32_16x16x32_bf16 v[144:147], v[168:171], v[88:91], v[144:147]
    buffer_load_dwordx4 v[204:207], v16, s[32:35], s28 offen offset:1024
    v_mfma_f32_16x16x32_bf16 v[148:151], v[172:175], v[88:91], v[148:151]
    v_mfma_f32_16x16x32_bf16 v[152:155], v[168:171], v[92:95], v[152:155]
    v_mfma_f32_16x16x32_bf16 v[156:159], v[172:175], v[92:95], v[156:159]
    s_waitcnt lgkmcnt(14)
    v_mfma_f32_16x16x32_bf16 v[248:251], v[32:35], v[32:35], v[248:251]
    ds_read_b64_tr_b16 v[64:65], v8 offset:24576
    v_mfma_f32_16x16x32_bf16 v[240:243], v[20:23], v[32:35], v[240:243]
    ds_read_b64_tr_b16 v[66:67], v8 offset:28672
    s_waitcnt lgkmcnt(14)
    v_mfma_f32_16x16x32_bf16 v[252:255], v[36:39], v[36:39], v[252:255]
    ds_read_b64_tr_b16 v[68:69], v9 offset:24576
    v_mfma_f32_16x16x32_bf16 v[244:247], v[20:23], v[36:39], v[244:247]
    ds_read_b64_tr_b16 v[70:71], v9 offset:28672
    s_waitcnt vmcnt(6)
    v_mfma_f32_16x16x32_bf16 v[96:99], v[176:179], v[32:35], v[96:99]
    ds_read_b64_tr_b16 v[72:73], v10 offset:24576
    v_mfma_f32_16x16x32_bf16 v[100:103], v[180:183], v[32:35], v[100:103]
    ds_read_b64_tr_b16 v[74:75], v10 offset:28672
    v_mfma_f32_16x16x32_bf16 v[104:107], v[176:179], v[36:39], v[104:107]
    ds_read_b64_tr_b16 v[76:77], v11 offset:24576
    v_mfma_f32_16x16x32_bf16 v[108:111], v[180:183], v[36:39], v[108:111]
    ds_read_b64_tr_b16 v[78:79], v11 offset:28672
    s_waitcnt lgkmcnt(15)
    v_mfma_f32_16x16x32_bf16 v[112:115], v[176:179], v[40:43], v[112:115]
    ds_read_b64_tr_b16 v[80:81], v12 offset:24576
    v_mfma_f32_16x16x32_bf16 v[116:119], v[180:183], v[40:43], v[116:119]
    ds_read_b64_tr_b16 v[82:83], v12 offset:28672
    v_mfma_f32_16x16x32_bf16 v[120:123], v[176:179], v[44:47], v[120:123]
    ds_read_b64_tr_b16 v[84:85], v13 offset:24576
    v_mfma_f32_16x16x32_bf16 v[124:127], v[180:183], v[44:47], v[124:127]
    ds_read_b64_tr_b16 v[86:87], v13 offset:28672
    s_waitcnt lgkmcnt(15)
    v_mfma_f32_16x16x32_bf16 v[128:131], v[176:179], v[48:51], v[128:131]
    ds_read_b64_tr_b16 v[88:89], v14 offset:24576
    v_mfma_f32_16x16x32_bf16 v[132:135], v[180:183], v[48:51], v[132:135]
    ds_read_b64_tr_b16 v[90:91], v14 offset:28672
    v_mfma_f32_16x16x32_bf16 v[136:139], v[176:179], v[52:55], v[136:139]
    ds_read_b64_tr_b16 v[92:93], v15 offset:24576
    v_mfma_f32_16x16x32_bf16 v[140:143], v[180:183], v[52:55], v[140:143]
    ds_read_b64_tr_b16 v[94:95], v15 offset:28672
    s_add_u32 s28, s27, 12288
    buffer_load_dwordx4 v[208:211], v16, s[32:35], s28 offen offset:0
    s_waitcnt lgkmcnt(15)
    v_mfma_f32_16x16x32_bf16 v[144:147], v[176:179], v[56:59], v[144:147]
    buffer_load_dwordx4 v[212:215], v16, s[32:35], s28 offen offset:1024
    v_mfma_f32_16x16x32_bf16 v[148:151], v[180:183], v[56:59], v[148:151]
    v_mfma_f32_16x16x32_bf16 v[152:155], v[176:179], v[60:63], v[152:155]
    v_mfma_f32_16x16x32_bf16 v[156:159], v[180:183], v[60:63], v[156:159]
    s_barrier
    s_waitcnt lgkmcnt(14)
    v_mfma_f32_16x16x32_bf16 v[248:251], v[64:67], v[64:67], v[248:251]
    ds_read_b64_tr_b16 v[32:33], v8 offset:32768
    v_mfma_f32_16x16x32_bf16 v[240:243], v[20:23], v[64:67], v[240:243]
    ds_read_b64_tr_b16 v[34:35], v8 offset:36864
    s_waitcnt lgkmcnt(14)
    v_mfma_f32_16x16x32_bf16 v[252:255], v[68:71], v[68:71], v[252:255]
    ds_read_b64_tr_b16 v[36:37], v9 offset:32768
    v_mfma_f32_16x16x32_bf16 v[244:247], v[20:23], v[68:71], v[244:247]
    ds_read_b64_tr_b16 v[38:39], v9 offset:36864
    s_waitcnt vmcnt(6)
    v_mfma_f32_16x16x32_bf16 v[96:99], v[184:187], v[64:67], v[96:99]
    ds_read_b64_tr_b16 v[40:41], v10 offset:32768
    v_mfma_f32_16x16x32_bf16 v[100:103], v[188:191], v[64:67], v[100:103]
    ds_read_b64_tr_b16 v[42:43], v10 offset:36864
    v_mfma_f32_16x16x32_bf16 v[104:107], v[184:187], v[68:71], v[104:107]
    ds_read_b64_tr_b16 v[44:45], v11 offset:32768
    v_mfma_f32_16x16x32_bf16 v[108:111], v[188:191], v[68:71], v[108:111]
    ds_read_b64_tr_b16 v[46:47], v11 offset:36864
    s_waitcnt lgkmcnt(15)
    v_mfma_f32_16x16x32_bf16 v[112:115], v[184:187], v[72:75], v[112:115]
    ds_read_b64_tr_b16 v[48:49], v12 offset:32768
    v_mfma_f32_16x16x32_bf16 v[116:119], v[188:191], v[72:75], v[116:119]
    ds_read_b64_tr_b16 v[50:51], v12 offset:36864
    v_mfma_f32_16x16x32_bf16 v[120:123], v[184:187], v[76:79], v[120:123]
    ds_read_b64_tr_b16 v[52:53], v13 offset:32768
    v_mfma_f32_16x16x32_bf16 v[124:127], v[188:191], v[76:79], v[124:127]
    ds_read_b64_tr_b16 v[54:55], v13 offset:36864
    s_waitcnt lgkmcnt(15)
    v_mfma_f32_16x16x32_bf16 v[128:131], v[184:187], v[80:83], v[128:131]
    ds_read_b64_tr_b16 v[56:57], v14 offset:32768
    v_mfma_f32_16x16x32_bf16 v[132:135], v[188:191], v[80:83], v[132:135]
    ds_read_b64_tr_b16 v[58:59], v14 offset:36864
    v_mfma_f32_16x16x32_bf16 v[136:139], v[184:187], v[84:87], v[136:139]
    ds_read_b64_tr_b16 v[60:61], v15 offset:32768
    v_mfma_f32_16x16x32_bf16 v[140:143], v[188:191], v[84:87], v[140:143]
    ds_read_b64_tr_b16 v[62:63], v15 offset:36864
    s_add_u32 s28, s27, 14336
    buffer_load_dwordx4 v[216:219], v16, s[32:35], s28 offen offset:0
    s_waitcnt lgkmcnt(15)
    v_mfma_f32_16x16x32_bf16 v[144:147], v[184:187], v[88:91], v[144:147]
    buffer_load_dwordx4 v[220:223], v16, s[32:35], s28 offen offset:1024
    v_mfma_f32_16x16x32_bf16 v[148:151], v[188:191], v[88:91], v[148:151]
    s_add_u32 s28, s27, 16384
    buffer_load_dwordx4 v[224:227], v16, s[32:35], s28 offen offset:0
    v_mfma_f32_16x16x32_bf16 v[152:155], v[184:187], v[92:95], v[152:155]
    buffer_load_dwordx4 v[228:231], v16, s[32:35], s28 offen offset:1024
    v_mfma_f32_16x16x32_bf16 v[156:159], v[188:191], v[92:95], v[156:159]
    s_waitcnt lgkmcnt(14)
    v_mfma_f32_16x16x32_bf16 v[248:251], v[32:35], v[32:35], v[248:251]
    ds_read_b64_tr_b16 v[64:65], v8 offset:40960
    v_mfma_f32_16x16x32_bf16 v[240:243], v[20:23], v[32:35], v[240:243]
    ds_read_b64_tr_b16 v[66:67], v8 offset:45056
    s_waitcnt lgkmcnt(14)
    v_mfma_f32_16x16x32_bf16 v[252:255], v[36:39], v[36:39], v[252:255]
    ds_read_b64_tr_b16 v[68:69], v9 offset:40960
    v_mfma_f32_16x16x32_bf16 v[244:247], v[20:23], v[36:39], v[244:247]
    ds_read_b64_tr_b16 v[70:71], v9 offset:45056
    s_waitcnt vmcnt(8)
    v_mfma_f32_16x16x32_bf16 v[96:99], v[192:195], v[32:35], v[96:99]
    ds_read_b64_tr_b16 v[72:73], v10 offset:40960
    v_mfma_f32_16x16x32_bf16 v[100:103], v[196:199], v[32:35], v[100:103]
    ds_read_b64_tr_b16 v[74:75], v10 offset:45056
    v_mfma_f32_16x16x32_bf16 v[104:107], v[192:195], v[36:39], v[104:107]
    ds_read_b64_tr_b16 v[76:77], v11 offset:40960
    v_mfma_f32_16x16x32_bf16 v[108:111], v[196:199], v[36:39], v[108:111]
    ds_read_b64_tr_b16 v[78:79], v11 offset:45056
    s_waitcnt lgkmcnt(15)
    v_mfma_f32_16x16x32_bf16 v[112:115], v[192:195], v[40:43], v[112:115]
    ds_read_b64_tr_b16 v[80:81], v12 offset:40960
    v_mfma_f32_16x16x32_bf16 v[116:119], v[196:199], v[40:43], v[116:119]
    ds_read_b64_tr_b16 v[82:83], v12 offset:45056
    v_mfma_f32_16x16x32_bf16 v[120:123], v[192:195], v[44:47], v[120:123]
    ds_read_b64_tr_b16 v[84:85], v13 offset:40960
    v_mfma_f32_16x16x32_bf16 v[124:127], v[196:199], v[44:47], v[124:127]
    ds_read_b64_tr_b16 v[86:87], v13 offset:45056
    s_waitcnt lgkmcnt(15)
    v_mfma_f32_16x16x32_bf16 v[128:131], v[192:195], v[48:51], v[128:131]
    ds_read_b64_tr_b16 v[88:89], v14 offset:40960
    v_mfma_f32_16x16x32_bf16 v[132:135], v[196:199], v[48:51], v[132:135]
    ds_read_b64_tr_b16 v[90:91], v14 offset:45056
    v_mfma_f32_16x16x32_bf16 v[136:139], v[192:195], v[52:55], v[136:139]
    ds_read_b64_tr_b16 v[92:93], v15 offset:40960
    v_mfma_f32_16x16x32_bf16 v[140:143], v[196:199], v[52:55], v[140:143]
    ds_read_b64_tr_b16 v[94:95], v15 offset:45056
    s_add_u32 s28, s27, 18432
    buffer_load_dwordx4 v[232:235], v16, s[32:35], s28 offen offset:0
    s_waitcnt lgkmcnt(15)
    v_mfma_f32_16x16x32_bf16 v[144:147], v[192:195], v[56:59], v[144:147]
    buffer_load_dwordx4 v[236:239], v16, s[32:35], s28 offen offset:1024
    v_mfma_f32_16x16x32_bf16 v[148:151], v[196:199], v[56:59], v[148:151]
    v_mfma_f32_16x16x32_bf16 v[152:155], v[192:195], v[60:63], v[152:155]
    v_mfma_f32_16x16x32_bf16 v[156:159], v[196:199], v[60:63], v[156:159]
    s_barrier
    s_waitcnt lgkmcnt(14)
    v_mfma_f32_16x16x32_bf16 v[248:251], v[64:67], v[64:67], v[248:251]
    ds_read_b64_tr_b16 v[32:33], v8 offset:49152
    v_mfma_f32_16x16x32_bf16 v[240:243], v[20:23], v[64:67], v[240:243]
    ds_read_b64_tr_b16 v[34:35], v8 offset:53248
    s_waitcnt lgkmcnt(14)
    v_mfma_f32_16x16x32_bf16 v[252:255], v[68:71], v[68:71], v[252:255]
    ds_read_b64_tr_b16 v[36:37], v9 offset:49152
    v_mfma_f32_16x16x32_bf16 v[244:247], v[20:23], v[68:71], v[244:247]
    ds_read_b64_tr_b16 v[38:39], v9 offset:53248
    s_waitcnt vmcnt(8)
    v_mfma_f32_16x16x32_bf16 v[96:99], v[200:203], v[64:67], v[96:99]
    ds_read_b64_tr_b16 v[40:41], v10 offset:49152
    v_mfma_f32_16x16x32_bf16 v[100:103], v[204:207], v[64:67], v[100:103]
    ds_read_b64_tr_b16 v[42:43], v10 offset:53248
    v_mfma_f32_16x16x32_bf16 v[104:107], v[200:203], v[68:71], v[104:107]
    ds_read_b64_tr_b16 v[44:45], v11 offset:49152
    v_mfma_f32_16x16x32_bf16 v[108:111], v[204:207], v[68:71], v[108:111]
    ds_read_b64_tr_b16 v[46:47], v11 offset:53248
    s_waitcnt lgkmcnt(15)
    v_mfma_f32_16x16x32_bf16 v[112:115], v[200:203], v[72:75], v[112:115]
    ds_read_b64_tr_b16 v[48:49], v12 offset:49152
    v_mfma_f32_16x16x32_bf16 v[116:119], v[204:207], v[72:75], v[116:119]
    ds_read_b64_tr_b16 v[50:51], v12 offset:53248
    v_mfma_f32_16x16x32_bf16 v[120:123], v[200:203], v[76:79], v[120:123]
    ds_read_b64_tr_b16 v[52:53], v13 offset:49152
    v_mfma_f32_16x16x32_bf16 v[124:127], v[204:207], v[76:79], v[124:127]
    ds_read_b64_tr_b16 v[54:55], v13 offset:53248
    s_waitcnt lgkmcnt(15)
    v_mfma_f32_16x16x32_bf16 v[128:131], v[200:203], v[80:83], v[128:131]
    ds_read_b64_tr_b16 v[56:57], v14 offset:49152
    v_mfma_f32_16x16x32_bf16 v[132:135], v[204:207], v[80:83], v[132:135]
    ds_read_b64_tr_b16 v[58:59], v14 offset:53248
    v_mfma_f32_16x16x32_bf16 v[136:139], v[200:203], v[84:87], v[136:139]
    ds_read_b64_tr_b16 v[60:61], v15 offset:49152
    v_mfma_f32_16x16x32_bf16 v[140:143], v[204:207], v[84:87], v[140:143]
    ds_read_b64_tr_b16 v[62:63], v15 offset:53248
    s_add_u32 s28, s27, 20480
    buffer_load_dwordx4 v[160:163], v16, s[32:35], s28 offen offset:0
    s_waitcnt lgkmcnt(15)
    v_mfma_f32_16x16x32_bf16 v[144:147], v[200:203], v[88:91], v[144:147]
    buffer_load_dwordx4 v[164:167], v16, s[32:35], s28 offen offset:1024
    v_mfma_f32_16x16x32_bf16 v[148:151], v[204:207], v[88:91], v[148:151]
    v_mfma_f32_16x16x32_bf16 v[152:155], v[200:203], v[92:95], v[152:155]
    v_mfma_f32_16x16x32_bf16 v[156:159], v[204:207], v[92:95], v[156:159]
    s_waitcnt lgkmcnt(14)
    v_mfma_f32_16x16x32_bf16 v[248:251], v[32:35], v[32:35], v[248:251]
    ds_read_b64_tr_b16 v[64:65], v8 offset:57344
    v_mfma_f32_16x16x32_bf16 v[240:243], v[20:23], v[32:35], v[240:243]
    ds_read_b64_tr_b16 v[66:67], v8 offset:61440
    s_waitcnt lgkmcnt(14)
    v_mfma_f32_16x16x32_bf16 v[252:255], v[36:39], v[36:39], v[252:255]
    ds_read_b64_tr_b16 v[68:69], v9 offset:57344
    v_mfma_f32_16x16x32_bf16 v[244:247], v[20:23], v[36:39], v[244:247]
    ds_read_b64_tr_b16 v[70:71], v9 offset:61440
    s_waitcnt vmcnt(8)
    v_mfma_f32_16x16x32_bf16 v[96:99], v[208:211], v[32:35], v[96:99]
    ds_read_b64_tr_b16 v[72:73], v10 offset:57344
    v_mfma_f32_16x16x32_bf16 v[100:103], v[212:215], v[32:35], v[100:103]
    ds_read_b64_tr_b16 v[74:75], v10 offset:61440
    v_mfma_f32_16x16x32_bf16 v[104:107], v[208:211], v[36:39], v[104:107]
    ds_read_b64_tr_b16 v[76:77], v11 offset:57344
    v_mfma_f32_16x16x32_bf16 v[108:111], v[212:215], v[36:39], v[108:111]
    ds_read_b64_tr_b16 v[78:79], v11 offset:61440
    s_waitcnt lgkmcnt(15)
    v_mfma_f32_16x16x32_bf16 v[112:115], v[208:211], v[40:43], v[112:115]
    ds_read_b64_tr_b16 v[80:81], v12 offset:57344
    v_mfma_f32_16x16x32_bf16 v[116:119], v[212:215], v[40:43], v[116:119]
    ds_read_b64_tr_b16 v[82:83], v12 offset:61440
    v_mfma_f32_16x16x32_bf16 v[120:123], v[208:211], v[44:47], v[120:123]
    ds_read_b64_tr_b16 v[84:85], v13 offset:57344
    v_mfma_f32_16x16x32_bf16 v[124:127], v[212:215], v[44:47], v[124:127]
    ds_read_b64_tr_b16 v[86:87], v13 offset:61440
    s_waitcnt lgkmcnt(15)
    v_mfma_f32_16x16x32_bf16 v[128:131], v[208:211], v[48:51], v[128:131]
    ds_read_b64_tr_b16 v[88:89], v14 offset:57344
    v_mfma_f32_16x16x32_bf16 v[132:135], v[212:215], v[48:51], v[132:135]
    ds_read_b64_tr_b16 v[90:91], v14 offset:61440
    v_mfma_f32_16x16x32_bf16 v[136:139], v[208:211], v[52:55], v[136:139]
    ds_read_b64_tr_b16 v[92:93], v15 offset:57344
    v_mfma_f32_16x16x32_bf16 v[140:143], v[212:215], v[52:55], v[140:143]
    ds_read_b64_tr_b16 v[94:95], v15 offset:61440
    s_add_u32 s28, s27, 22528
    buffer_load_dwordx4 v[168:171], v16, s[32:35], s28 offen offset:0
    s_waitcnt lgkmcnt(15)
    v_mfma_f32_16x16x32_bf16 v[144:147], v[208:211], v[56:59], v[144:147]
    buffer_load_dwordx4 v[172:175], v16, s[32:35], s28 offen offset:1024
    v_mfma_f32_16x16x32_bf16 v[148:151], v[212:215], v[56:59], v[148:151]
    v_mfma_f32_16x16x32_bf16 v[152:155], v[208:211], v[60:63], v[152:155]
    v_mfma_f32_16x16x32_bf16 v[156:159], v[212:215], v[60:63], v[156:159]
    s_barrier
    v_xor_b32 v8, 0x10000, v8
    v_xor_b32 v9, 0x10000, v9
    v_xor_b32 v10, 0x10000, v10
    v_xor_b32 v11, 0x10000, v11
    v_xor_b32 v12, 0x10000, v12
    v_xor_b32 v13, 0x10000, v13
    v_xor_b32 v14, 0x10000, v14
    v_xor_b32 v15, 0x10000, v15
    s_waitcnt lgkmcnt(14)
    v_mfma_f32_16x16x32_bf16 v[248:251], v[64:67], v[64:67], v[248:251]
    ds_read_b64_tr_b16 v[32:33], v8 offset:0
    v_mfma_f32_16x16x32_bf16 v[240:243], v[20:23], v[64:67], v[240:243]
    ds_read_b64_tr_b16 v[34:35], v8 offset:4096
    s_waitcnt lgkmcnt(14)
    v_mfma_f32_16x16x32_bf16 v[252:255], v[68:71], v[68:71], v[252:255]
    ds_read_b64_tr_b16 v[36:37], v9 offset:0
    v_mfma_f32_16x16x32_bf16 v[244:247], v[20:23], v[68:71], v[244:247]
    ds_read_b64_tr_b16 v[38:39], v9 offset:4096
    s_waitcnt vmcnt(8)
    v_mfma_f32_16x16x32_bf16 v[96:99], v[216:219], v[64:67], v[96:99]
    ds_read_b64_tr_b16 v[40:41], v10 offset:0
    v_mfma_f32_16x16x32_bf16 v[100:103], v[220:223], v[64:67], v[100:103]
    ds_read_b64_tr_b16 v[42:43], v10 offset:4096
    v_mfma_f32_16x16x32_bf16 v[104:107], v[216:219], v[68:71], v[104:107]
    ds_read_b64_tr_b16 v[44:45], v11 offset:0
    v_mfma_f32_16x16x32_bf16 v[108:111], v[220:223], v[68:71], v[108:111]
    ds_read_b64_tr_b16 v[46:47], v11 offset:4096
    s_waitcnt lgkmcnt(15)
    v_mfma_f32_16x16x32_bf16 v[112:115], v[216:219], v[72:75], v[112:115]
    ds_read_b64_tr_b16 v[48:49], v12 offset:0
    v_mfma_f32_16x16x32_bf16 v[116:119], v[220:223], v[72:75], v[116:119]
    ds_read_b64_tr_b16 v[50:51], v12 offset:4096
    v_mfma_f32_16x16x32_bf16 v[120:123], v[216:219], v[76:79], v[120:123]
    ds_read_b64_tr_b16 v[52:53], v13 offset:0
    v_mfma_f32_16x16x32_bf16 v[124:127], v[220:223], v[76:79], v[124:127]
    ds_read_b64_tr_b16 v[54:55], v13 offset:4096
    s_waitcnt lgkmcnt(15)
    v_mfma_f32_16x16x32_bf16 v[128:131], v[216:219], v[80:83], v[128:131]
    ds_read_b64_tr_b16 v[56:57], v14 offset:0
    v_mfma_f32_16x16x32_bf16 v[132:135], v[220:223], v[80:83], v[132:135]
    ds_read_b64_tr_b16 v[58:59], v14 offset:4096
    v_mfma_f32_16x16x32_bf16 v[136:139], v[216:219], v[84:87], v[136:139]
    ds_read_b64_tr_b16 v[60:61], v15 offset:0
    v_mfma_f32_16x16x32_bf16 v[140:143], v[220:223], v[84:87], v[140:143]
    ds_read_b64_tr_b16 v[62:63], v15 offset:4096
    s_add_u32 s28, s27, 24576
    buffer_load_dwordx4 v[176:179], v16, s[32:35], s28 offen offset:0
    s_waitcnt lgkmcnt(15)
    v_mfma_f32_16x16x32_bf16 v[144:147], v[216:219], v[88:91], v[144:147]
    buffer_load_dwordx4 v[180:183], v16, s[32:35], s28 offen offset:1024
    v_mfma_f32_16x16x32_bf16 v[148:151], v[220:223], v[88:91], v[148:151]
    s_add_u32 s28, s27, 26624
    buffer_load_dwordx4 v[184:187], v16, s[32:35], s28 offen offset:0
    v_mfma_f32_16x16x32_bf16 v[152:155], v[216:219], v[92:95], v[152:155]
    buffer_load_dwordx4 v[188:191], v16, s[32:35], s28 offen offset:1024
    v_mfma_f32_16x16x32_bf16 v[156:159], v[220:223], v[92:95], v[156:159]
    s_waitcnt lgkmcnt(14)
    v_mfma_f32_16x16x32_bf16 v[248:251], v[32:35], v[32:35], v[248:251]
    ds_read_b64_tr_b16 v[64:65], v8 offset:8192
    v_mfma_f32_16x16x32_bf16 v[240:243], v[20:23], v[32:35], v[240:243]
    ds_read_b64_tr_b16 v[66:67], v8 offset:12288
    s_waitcnt lgkmcnt(14)
    v_mfma_f32_16x16x32_bf16 v[252:255], v[36:39], v[36:39], v[252:255]
    ds_read_b64_tr_b16 v[68:69], v9 offset:8192
    v_mfma_f32_16x16x32_bf16 v[244:247], v[20:23], v[36:39], v[244:247]
    ds_read_b64_tr_b16 v[70:71], v9 offset:12288
    s_waitcnt vmcnt(10)
    v_mfma_f32_16x16x32_bf16 v[96:99], v[224:227], v[32:35], v[96:99]
    ds_read_b64_tr_b16 v[72:73], v10 offset:8192
    v_mfma_f32_16x16x32_bf16 v[100:103], v[228:231], v[32:35], v[100:103]
    ds_read_b64_tr_b16 v[74:75], v10 offset:12288
    v_mfma_f32_16x16x32_bf16 v[104:107], v[224:227], v[36:39], v[104:107]
    ds_read_b64_tr_b16 v[76:77], v11 offset:8192
    v_mfma_f32_16x16x32_bf16 v[108:111], v[228:231], v[36:39], v[108:111]
    ds_read_b64_tr_b16 v[78:79], v11 offset:12288
    s_waitcnt lgkmcnt(15)
    v_mfma_f32_16x16x32_bf16 v[112:115], v[224:227], v[40:43], v[112:115]
    ds_read_b64_tr_b16 v[80:81], v12 offset:8192
    v_mfma_f32_16x16x32_bf16 v[116:119], v[228:231], v[40:43], v[116:119]
    ds_read_b64_tr_b16 v[82:83], v12 offset:12288
    v_mfma_f32_16x16x32_bf16 v[120:123], v[224:227], v[44:47], v[120:123]
    ds_read_b64_tr_b16 v[84:85], v13 offset:8192
    v_mfma_f32_16x16x32_bf16 v[124:127], v[228:231], v[44:47], v[124:127]
    ds_read_b64_tr_b16 v[86:87], v13 offset:12288
    s_waitcnt lgkmcnt(15)
    v_mfma_f32_16x16x32_bf16 v[128:131], v[224:227], v[48:51], v[128:131]
    ds_read_b64_tr_b16 v[88:89], v14 offset:8192
    v_mfma_f32_16x16x32_bf16 v[132:135], v[228:231], v[48:51], v[132:135]
    ds_read_b64_tr_b16 v[90:91], v14 offset:12288
    v_mfma_f32_16x16x32_bf16 v[136:139], v[224:227], v[52:55], v[136:139]
    ds_read_b64_tr_b16 v[92:93], v15 offset:8192
    v_mfma_f32_16x16x32_bf16 v[140:143], v[228:231], v[52:55], v[140:143]
    ds_read_b64_tr_b16 v[94:95], v15 offset:12288
    s_add_u32 s28, s27, 28672
    buffer_load_dwordx4 v[192:195], v16, s[32:35], s28 offen offset:0
    s_waitcnt lgkmcnt(15)
    v_mfma_f32_16x16x32_bf16 v[144:147], v[224:227], v[56:59], v[144:147]
    buffer_load_dwordx4 v[196:199], v16, s[32:35], s28 offen offset:1024
    v_mfma_f32_16x16x32_bf16 v[148:151], v[228:231], v[56:59], v[148:151]
    v_mfma_f32_16x16x32_bf16 v[152:155], v[224:227], v[60:63], v[152:155]
    v_mfma_f32_16x16x32_bf16 v[156:159], v[228:231], v[60:63], v[156:159]
    s_barrier
    s_waitcnt lgkmcnt(14)
    v_mfma_f32_16x16x32_bf16 v[248:251], v[64:67], v[64:67], v[248:251]
    ds_read_b64_tr_b16 v[32:33], v8 offset:16384
    v_mfma_f32_16x16x32_bf16 v[240:243], v[20:23], v[64:67], v[240:243]
    ds_read_b64_tr_b16 v[34:35], v8 offset:20480
    s_waitcnt lgkmcnt(14)
    v_mfma_f32_16x16x32_bf16 v[252:255], v[68:71], v[68:71], v[252:255]
    ds_read_b64_tr_b16 v[36:37], v9 offset:16384
    v_mfma_f32_16x16x32_bf16 v[244:247], v[20:23], v[68:71], v[244:247]
    ds_read_b64_tr_b16 v[38:39], v9 offset:20480
    s_waitcnt vmcnt(10)
    v_mfma_f32_16x16x32_bf16 v[96:99], v[232:235], v[64:67], v[96:99]
    ds_read_b64_tr_b16 v[40:41], v10 offset:16384
    v_mfma_f32_16x16x32_bf16 v[100:103], v[236:239], v[64:67], v[100:103]
    ds_read_b64_tr_b16 v[42:43], v10 offset:20480
    v_mfma_f32_16x16x32_bf16 v[104:107], v[232:235], v[68:71], v[104:107]
    ds_read_b64_tr_b16 v[44:45], v11 offset:16384
    v_mfma_f32_16x16x32_bf16 v[108:111], v[236:239], v[68:71], v[108:111]
    ds_read_b64_tr_b16 v[46:47], v11 offset:20480
    s_waitcnt lgkmcnt(15)
    v_mfma_f32_16x16x32_bf16 v[112:115], v[232:235], v[72:75], v[112:115]
    ds_read_b64_tr_b16 v[48:49], v12 offset:16384
    v_mfma_f32_16x16x32_bf16 v[116:119], v[236:239], v[72:75], v[116:119]
    ds_read_b64_tr_b16 v[50:51], v12 offset:20480
    v_mfma_f32_16x16x32_bf16 v[120:123], v[232:235], v[76:79], v[120:123]
    ds_read_b64_tr_b16 v[52:53], v13 offset:16384
    v_mfma_f32_16x16x32_bf16 v[124:127], v[236:239], v[76:79], v[124:127]
    ds_read_b64_tr_b16 v[54:55], v13 offset:20480
    s_waitcnt lgkmcnt(15)
    v_mfma_f32_16x16x32_bf16 v[128:131], v[232:235], v[80:83], v[128:131]
    ds_read_b64_tr_b16 v[56:57], v14 offset:16384
    v_mfma_f32_16x16x32_bf16 v[132:135], v[236:239], v[80:83], v[132:135]
    ds_read_b64_tr_b16 v[58:59], v14 offset:20480
    v_mfma_f32_16x16x32_bf16 v[136:139], v[232:235], v[84:87], v[136:139]
    ds_read_b64_tr_b16 v[60:61], v15 offset:16384
    v_mfma_f32_16x16x32_bf16 v[140:143], v[236:239], v[84:87], v[140:143]
    ds_read_b64_tr_b16 v[62:63], v15 offset:20480
    s_add_u32 s28, s27, 30720
    buffer_load_dwordx4 v[200:203], v16, s[32:35], s28 offen offset:0
    s_waitcnt lgkmcnt(15)
    v_mfma_f32_16x16x32_bf16 v[144:147], v[232:235], v[88:91], v[144:147]
    buffer_load_dwordx4 v[204:207], v16, s[32:35], s28 offen offset:1024
    v_mfma_f32_16x16x32_bf16 v[148:151], v[236:239], v[88:91], v[148:151]
    v_mfma_f32_16x16x32_bf16 v[152:155], v[232:235], v[92:95], v[152:155]
    v_mfma_f32_16x16x32_bf16 v[156:159], v[236:239], v[92:95], v[156:159]
    s_waitcnt lgkmcnt(14)
    v_mfma_f32_16x16x32_bf16 v[248:251], v[32:35], v[32:35], v[248:251]
    ds_read_b64_tr_b16 v[64:65], v8 offset:24576
    v_mfma_f32_16x16x32_bf16 v[240:243], v[20:23], v[32:35], v[240:243]
    ds_read_b64_tr_b16 v[66:67], v8 offset:28672
    s_waitcnt lgkmcnt(14)
    v_mfma_f32_16x16x32_bf16 v[252:255], v[36:39], v[36:39], v[252:255]
    ds_read_b64_tr_b16 v[68:69], v9 offset:24576
    v_mfma_f32_16x16x32_bf16 v[244:247], v[20:23], v[36:39], v[244:247]
    ds_read_b64_tr_b16 v[70:71], v9 offset:28672
    s_waitcnt vmcnt(10)
    v_mfma_f32_16x16x32_bf16 v[96:99], v[160:163], v[32:35], v[96:99]
    ds_read_b64_tr_b16 v[72:73], v10 offset:24576
    v_mfma_f32_16x16x32_bf16 v[100:103], v[164:167], v[32:35], v[100:103]
    ds_read_b64_tr_b16 v[74:75], v10 offset:28672
    v_mfma_f32_16x16x32_bf16 v[104:107], v[160:163], v[36:39], v[104:107]
    ds_read_b64_tr_b16 v[76:77], v11 offset:24576
    v_mfma_f32_16x16x32_bf16 v[108:111], v[164:167], v[36:39], v[108:111]
    ds_read_b64_tr_b16 v[78:79], v11 offset:28672
    s_waitcnt lgkmcnt(15)
    v_mfma_f32_16x16x32_bf16 v[112:115], v[160:163], v[40:43], v[112:115]
    ds_read_b64_tr_b16 v[80:81], v12 offset:24576
    v_mfma_f32_16x16x32_bf16 v[116:119], v[164:167], v[40:43], v[116:119]
    ds_read_b64_tr_b16 v[82:83], v12 offset:28672
    v_mfma_f32_16x16x32_bf16 v[120:123], v[160:163], v[44:47], v[120:123]
    ds_read_b64_tr_b16 v[84:85], v13 offset:24576
    v_mfma_f32_16x16x32_bf16 v[124:127], v[164:167], v[44:47], v[124:127]
    ds_read_b64_tr_b16 v[86:87], v13 offset:28672
    s_waitcnt lgkmcnt(15)
    v_mfma_f32_16x16x32_bf16 v[128:131], v[160:163], v[48:51], v[128:131]
    ds_read_b64_tr_b16 v[88:89], v14 offset:24576
    v_mfma_f32_16x16x32_bf16 v[132:135], v[164:167], v[48:51], v[132:135]
    ds_read_b64_tr_b16 v[90:91], v14 offset:28672
    v_mfma_f32_16x16x32_bf16 v[136:139], v[160:163], v[52:55], v[136:139]
    ds_read_b64_tr_b16 v[92:93], v15 offset:24576
    v_mfma_f32_16x16x32_bf16 v[140:143], v[164:167], v[52:55], v[140:143]
    ds_read_b64_tr_b16 v[94:95], v15 offset:28672
    s_add_u32 s28, s27, 32768
    buffer_load_dwordx4 v[208:211], v16, s[32:35], s28 offen offset:0
    s_waitcnt lgkmcnt(15)
    v_mfma_f32_16x16x32_bf16 v[144:147], v[160:163], v[56:59], v[144:147]
    buffer_load_dwordx4 v[212:215], v16, s[32:35], s28 offen offset:1024
    v_mfma_f32_16x16x32_bf16 v[148:151], v[164:167], v[56:59], v[148:151]
    v_mfma_f32_16x16x32_bf16 v[152:155], v[160:163], v[60:63], v[152:155]
    v_mfma_f32_16x16x32_bf16 v[156:159], v[164:167], v[60:63], v[156:159]
    s_waitcnt lgkmcnt(14)
    v_mfma_f32_16x16x32_bf16 v[248:251], v[64:67], v[64:67], v[248:251]
    ds_read_b64_tr_b16 v[32:33], v8 offset:32768
    v_mfma_f32_16x16x32_bf16 v[240:243], v[20:23], v[64:67], v[240:243]
    ds_read_b64_tr_b16 v[34:35], v8 offset:36864
    s_waitcnt lgkmcnt(14)
    v_mfma_f32_16x16x32_bf16 v[252:255], v[68:71], v[68:71], v[252:255]
    ds_read_b64_tr_b16 v[36:37], v9 offset:32768
    v_mfma_f32_16x16x32_bf16 v[244:247], v[20:23], v[68:71], v[244:247]
    ds_read_b64_tr_b16 v[38:39], v9 offset:36864
    s_waitcnt vmcnt(10)
    v_mfma_f32_16x16x32_bf16 v[96:99], v[168:171], v[64:67], v[96:99]
    ds_read_b64_tr_b16 v[40:41], v10 offset:32768
    v_mfma_f32_16x16x32_bf16 v[100:103], v[172:175], v[64:67], v[100:103]
    ds_read_b64_tr_b16 v[42:43], v10 offset:36864
    v_mfma_f32_16x16x32_bf16 v[104:107], v[168:171], v[68:71], v[104:107]
    ds_read_b64_tr_b16 v[44:45], v11 offset:32768
    v_mfma_f32_16x16x32_bf16 v[108:111], v[172:175], v[68:71], v[108:111]
    ds_read_b64_tr_b16 v[46:47], v11 offset:36864
    s_waitcnt lgkmcnt(15)
    v_mfma_f32_16x16x32_bf16 v[112:115], v[168:171], v[72:75], v[112:115]
    ds_read_b64_tr_b16 v[48:49], v12 offset:32768
    v_mfma_f32_16x16x32_bf16 v[116:119], v[172:175], v[72:75], v[116:119]
    ds_read_b64_tr_b16 v[50:51], v12 offset:36864
    v_mfma_f32_16x16x32_bf16 v[120:123], v[168:171], v[76:79], v[120:123]
    ds_read_b64_tr_b16 v[52:53], v13 offset:32768
    v_mfma_f32_16x16x32_bf16 v[124:127], v[172:175], v[76:79], v[124:127]
    ds_read_b64_tr_b16 v[54:55], v13 offset:36864
    s_waitcnt lgkmcnt(15)
    v_mfma_f32_16x16x32_bf16 v[128:131], v[168:171], v[80:83], v[128:131]
    ds_read_b64_tr_b16 v[56:57], v14 offset:32768
    v_mfma_f32_16x16x32_bf16 v[132:135], v[172:175], v[80:83], v[132:135]
    ds_read_b64_tr_b16 v[58:59], v14 offset:36864
    v_mfma_f32_16x16x32_bf16 v[136:139], v[168:171], v[84:87], v[136:139]
    ds_read_b64_tr_b16 v[60:61], v15 offset:32768
    v_mfma_f32_16x16x32_bf16 v[140:143], v[172:175], v[84:87], v[140:143]
    ds_read_b64_tr_b16 v[62:63], v15 offset:36864
    s_add_u32 s28, s27, 34816
    buffer_load_dwordx4 v[216:219], v16, s[32:35], s28 offen offset:0
    s_waitcnt lgkmcnt(15)
    v_mfma_f32_16x16x32_bf16 v[144:147], v[168:171], v[88:91], v[144:147]
    buffer_load_dwordx4 v[220:223], v16, s[32:35], s28 offen offset:1024
    v_mfma_f32_16x16x32_bf16 v[148:151], v[172:175], v[88:91], v[148:151]
    s_add_u32 s28, s27, 36864
    buffer_load_dwordx4 v[224:227], v16, s[32:35], s28 offen offset:0
    v_mfma_f32_16x16x32_bf16 v[152:155], v[168:171], v[92:95], v[152:155]
    buffer_load_dwordx4 v[228:231], v16, s[32:35], s28 offen offset:1024
    v_mfma_f32_16x16x32_bf16 v[156:159], v[172:175], v[92:95], v[156:159]
    s_waitcnt lgkmcnt(14)
    v_mfma_f32_16x16x32_bf16 v[248:251], v[32:35], v[32:35], v[248:251]
    ds_read_b64_tr_b16 v[64:65], v8 offset:40960
    v_mfma_f32_16x16x32_bf16 v[240:243], v[20:23], v[32:35], v[240:243]
    ds_read_b64_tr_b16 v[66:67], v8 offset:45056
    s_waitcnt lgkmcnt(14)
    v_mfma_f32_16x16x32_bf16 v[252:255], v[36:39], v[36:39], v[252:255]
    ds_read_b64_tr_b16 v[68:69], v9 offset:40960
    v_mfma_f32_16x16x32_bf16 v[244:247], v[20:23], v[36:39], v[244:247]
    ds_read_b64_tr_b16 v[70:71], v9 offset:45056
    s_waitcnt vmcnt(12)
    v_mfma_f32_16x16x32_bf16 v[96:99], v[176:179], v[32:35], v[96:99]
    ds_read_b64_tr_b16 v[72:73], v10 offset:40960
    v_mfma_f32_16x16x32_bf16 v[100:103], v[180:183], v[32:35], v[100:103]
    ds_read_b64_tr_b16 v[74:75], v10 offset:45056
    v_mfma_f32_16x16x32_bf16 v[104:107], v[176:179], v[36:39], v[104:107]
    ds_read_b64_tr_b16 v[76:77], v11 offset:40960
    v_mfma_f32_16x16x32_bf16 v[108:111], v[180:183], v[36:39], v[108:111]
    ds_read_b64_tr_b16 v[78:79], v11 offset:45056
    s_waitcnt lgkmcnt(15)
    v_mfma_f32_16x16x32_bf16 v[112:115], v[176:179], v[40:43], v[112:115]
    ds_read_b64_tr_b16 v[80:81], v12 offset:40960
    v_mfma_f32_16x16x32_bf16 v[116:119], v[180:183], v[40:43], v[116:119]
    ds_read_b64_tr_b16 v[82:83], v12 offset:45056
    v_mfma_f32_16x16x32_bf16 v[120:123], v[176:179], v[44:47], v[120:123]
    ds_read_b64_tr_b16 v[84:85], v13 offset:40960
    v_mfma_f32_16x16x32_bf16 v[124:127], v[180:183], v[44:47], v[124:127]
    ds_read_b64_tr_b16 v[86:87], v13 offset:45056
    s_waitcnt lgkmcnt(15)
    v_mfma_f32_16x16x32_bf16 v[128:131], v[176:179], v[48:51], v[128:131]
    ds_read_b64_tr_b16 v[88:89], v14 offset:40960
    v_mfma_f32_16x16x32_bf16 v[132:135], v[180:183], v[48:51], v[132:135]
    ds_read_b64_tr_b16 v[90:91], v14 offset:45056
    v_mfma_f32_16x16x32_bf16 v[136:139], v[176:179], v[52:55], v[136:139]
    ds_read_b64_tr_b16 v[92:93], v15 offset:40960
    v_mfma_f32_16x16x32_bf16 v[140:143], v[180:183], v[52:55], v[140:143]
    ds_read_b64_tr_b16 v[94:95], v15 offset:45056
    s_add_u32 s28, s27, 38912
    buffer_load_dwordx4 v[232:235], v16, s[32:35], s28 offen offset:0
    s_waitcnt lgkmcnt(15)
    v_mfma_f32_16x16x32_bf16 v[144:147], v[176:179], v[56:59], v[144:147]
    buffer_load_dwordx4 v[236:239], v16, s[32:35], s28 offen offset:1024
    v_mfma_f32_16x16x32_bf16 v[148:151], v[180:183], v[56:59], v[148:151]
    v_mfma_f32_16x16x32_bf16 v[152:155], v[176:179], v[60:63], v[152:155]
    v_mfma_f32_16x16x32_bf16 v[156:159], v[180:183], v[60:63], v[156:159]
    s_barrier
    s_waitcnt lgkmcnt(14)
    v_mfma_f32_16x16x32_bf16 v[248:251], v[64:67], v[64:67], v[248:251]
    ds_read_b64_tr_b16 v[32:33], v8 offset:49152
    v_mfma_f32_16x16x32_bf16 v[240:243], v[20:23], v[64:67], v[240:243]
    ds_read_b64_tr_b16 v[34:35], v8 offset:53248
    s_waitcnt lgkmcnt(14)
    v_mfma_f32_16x16x32_bf16 v[252:255], v[68:71], v[68:71], v[252:255]
    ds_read_b64_tr_b16 v[36:37], v9 offset:49152
    v_mfma_f32_16x16x32_bf16 v[244:247], v[20:23], v[68:71], v[244:247]
    ds_read_b64_tr_b16 v[38:39], v9 offset:53248
    s_waitcnt vmcnt(12)
    v_mfma_f32_16x16x32_bf16 v[96:99], v[184:187], v[64:67], v[96:99]
    ds_read_b64_tr_b16 v[40:41], v10 offset:49152
    v_mfma_f32_16x16x32_bf16 v[100:103], v[188:191], v[64:67], v[100:103]
    ds_read_b64_tr_b16 v[42:43], v10 offset:53248
    v_mfma_f32_16x16x32_bf16 v[104:107], v[184:187], v[68:71], v[104:107]
    ds_read_b64_tr_b16 v[44:45], v11 offset:49152
    v_mfma_f32_16x16x32_bf16 v[108:111], v[188:191], v[68:71], v[108:111]
    ds_read_b64_tr_b16 v[46:47], v11 offset:53248
    s_waitcnt lgkmcnt(15)
    v_mfma_f32_16x16x32_bf16 v[112:115], v[184:187], v[72:75], v[112:115]
    ds_read_b64_tr_b16 v[48:49], v12 offset:49152
    v_mfma_f32_16x16x32_bf16 v[116:119], v[188:191], v[72:75], v[116:119]
    ds_read_b64_tr_b16 v[50:51], v12 offset:53248
    v_mfma_f32_16x16x32_bf16 v[120:123], v[184:187], v[76:79], v[120:123]
    ds_read_b64_tr_b16 v[52:53], v13 offset:49152
    v_mfma_f32_16x16x32_bf16 v[124:127], v[188:191], v[76:79], v[124:127]
    ds_read_b64_tr_b16 v[54:55], v13 offset:53248
    s_waitcnt lgkmcnt(15)
    v_mfma_f32_16x16x32_bf16 v[128:131], v[184:187], v[80:83], v[128:131]
    ds_read_b64_tr_b16 v[56:57], v14 offset:49152
    v_mfma_f32_16x16x32_bf16 v[132:135], v[188:191], v[80:83], v[132:135]
    ds_read_b64_tr_b16 v[58:59], v14 offset:53248
    v_mfma_f32_16x16x32_bf16 v[136:139], v[184:187], v[84:87], v[136:139]
    ds_read_b64_tr_b16 v[60:61], v15 offset:49152
    v_mfma_f32_16x16x32_bf16 v[140:143], v[188:191], v[84:87], v[140:143]
    ds_read_b64_tr_b16 v[62:63], v15 offset:53248
    s_add_u32 s28, s27, 40960
    buffer_load_dwordx2 v[160:161], v16, s[32:35], s28 offen offset:0
    s_waitcnt lgkmcnt(15)
    v_mfma_f32_16x16x32_bf16 v[144:147], v[184:187], v[88:91], v[144:147]
    buffer_load_dwordx2 v[164:165], v16, s[32:35], s28 offen offset:1024
    v_mfma_f32_16x16x32_bf16 v[148:151], v[188:191], v[88:91], v[148:151]
    v_mfma_f32_16x16x32_bf16 v[152:155], v[184:187], v[92:95], v[152:155]
    v_mfma_f32_16x16x32_bf16 v[156:159], v[188:191], v[92:95], v[156:159]
    s_waitcnt lgkmcnt(14)
    v_mfma_f32_16x16x32_bf16 v[248:251], v[32:35], v[32:35], v[248:251]
    ds_read_b64_tr_b16 v[64:65], v8 offset:57344
    v_mfma_f32_16x16x32_bf16 v[240:243], v[20:23], v[32:35], v[240:243]
    ds_read_b64_tr_b16 v[66:67], v8 offset:61440
    s_waitcnt lgkmcnt(14)
    v_mfma_f32_16x16x32_bf16 v[252:255], v[36:39], v[36:39], v[252:255]
    ds_read_b64_tr_b16 v[68:69], v9 offset:57344
    v_mfma_f32_16x16x32_bf16 v[244:247], v[20:23], v[36:39], v[244:247]
    ds_read_b64_tr_b16 v[70:71], v9 offset:61440
    s_waitcnt vmcnt(12)
    v_mfma_f32_16x16x32_bf16 v[96:99], v[192:195], v[32:35], v[96:99]
    ds_read_b64_tr_b16 v[72:73], v10 offset:57344
    v_mfma_f32_16x16x32_bf16 v[100:103], v[196:199], v[32:35], v[100:103]
    ds_read_b64_tr_b16 v[74:75], v10 offset:61440
    v_mfma_f32_16x16x32_bf16 v[104:107], v[192:195], v[36:39], v[104:107]
    ds_read_b64_tr_b16 v[76:77], v11 offset:57344
    v_mfma_f32_16x16x32_bf16 v[108:111], v[196:199], v[36:39], v[108:111]
    ds_read_b64_tr_b16 v[78:79], v11 offset:61440
    s_waitcnt lgkmcnt(15)
    v_mfma_f32_16x16x32_bf16 v[112:115], v[192:195], v[40:43], v[112:115]
    ds_read_b64_tr_b16 v[80:81], v12 offset:57344
    v_mfma_f32_16x16x32_bf16 v[116:119], v[196:199], v[40:43], v[116:119]
    ds_read_b64_tr_b16 v[82:83], v12 offset:61440
    v_mfma_f32_16x16x32_bf16 v[120:123], v[192:195], v[44:47], v[120:123]
    ds_read_b64_tr_b16 v[84:85], v13 offset:57344
    v_mfma_f32_16x16x32_bf16 v[124:127], v[196:199], v[44:47], v[124:127]
    ds_read_b64_tr_b16 v[86:87], v13 offset:61440
    s_waitcnt lgkmcnt(15)
    v_mfma_f32_16x16x32_bf16 v[128:131], v[192:195], v[48:51], v[128:131]
    ds_read_b64_tr_b16 v[88:89], v14 offset:57344
    v_mfma_f32_16x16x32_bf16 v[132:135], v[196:199], v[48:51], v[132:135]
    ds_read_b64_tr_b16 v[90:91], v14 offset:61440
    v_mfma_f32_16x16x32_bf16 v[136:139], v[192:195], v[52:55], v[136:139]
    ds_read_b64_tr_b16 v[92:93], v15 offset:57344
    v_mfma_f32_16x16x32_bf16 v[140:143], v[196:199], v[52:55], v[140:143]
    ds_read_b64_tr_b16 v[94:95], v15 offset:61440
    s_waitcnt lgkmcnt(15)
    v_mfma_f32_16x16x32_bf16 v[144:147], v[192:195], v[56:59], v[144:147]
    v_mfma_f32_16x16x32_bf16 v[148:151], v[196:199], v[56:59], v[148:151]
    v_mfma_f32_16x16x32_bf16 v[152:155], v[192:195], v[60:63], v[152:155]
    v_mfma_f32_16x16x32_bf16 v[156:159], v[196:199], v[60:63], v[156:159]
    v_xor_b32 v8, 0x10000, v8
    v_xor_b32 v9, 0x10000, v9
    v_xor_b32 v10, 0x10000, v10
    v_xor_b32 v11, 0x10000, v11
    v_xor_b32 v12, 0x10000, v12
    v_xor_b32 v13, 0x10000, v13
    v_xor_b32 v14, 0x10000, v14
    v_xor_b32 v15, 0x10000, v15
    s_waitcnt lgkmcnt(14)
    v_mfma_f32_16x16x32_bf16 v[248:251], v[64:67], v[64:67], v[248:251]
    ds_read_b64_tr_b16 v[32:33], v8 offset:0
    v_mfma_f32_16x16x32_bf16 v[240:243], v[20:23], v[64:67], v[240:243]
    ds_read_b64_tr_b16 v[34:35], v8 offset:4096
    s_waitcnt lgkmcnt(14)
    v_mfma_f32_16x16x32_bf16 v[252:255], v[68:71], v[68:71], v[252:255]
    ds_read_b64_tr_b16 v[36:37], v9 offset:0
    v_mfma_f32_16x16x32_bf16 v[244:247], v[20:23], v[68:71], v[244:247]
    ds_read_b64_tr_b16 v[38:39], v9 offset:4096
    s_waitcnt vmcnt(10)
    v_mfma_f32_16x16x32_bf16 v[96:99], v[200:203], v[64:67], v[96:99]
    ds_read_b64_tr_b16 v[40:41], v10 offset:0
    v_mfma_f32_16x16x32_bf16 v[100:103], v[204:207], v[64:67], v[100:103]
    ds_read_b64_tr_b16 v[42:43], v10 offset:4096
    v_mfma_f32_16x16x32_bf16 v[104:107], v[200:203], v[68:71], v[104:107]
    ds_read_b64_tr_b16 v[44:45], v11 offset:0
    v_mfma_f32_16x16x32_bf16 v[108:111], v[204:207], v[68:71], v[108:111]
    ds_read_b64_tr_b16 v[46:47], v11 offset:4096
    s_waitcnt lgkmcnt(15)
    v_mfma_f32_16x16x32_bf16 v[112:115], v[200:203], v[72:75], v[112:115]
    ds_read_b64_tr_b16 v[48:49], v12 offset:0
    v_mfma_f32_16x16x32_bf16 v[116:119], v[204:207], v[72:75], v[116:119]
    ds_read_b64_tr_b16 v[50:51], v12 offset:4096
    v_mfma_f32_16x16x32_bf16 v[120:123], v[200:203], v[76:79], v[120:123]
    ds_read_b64_tr_b16 v[52:53], v13 offset:0
    v_mfma_f32_16x16x32_bf16 v[124:127], v[204:207], v[76:79], v[124:127]
    ds_read_b64_tr_b16 v[54:55], v13 offset:4096
    s_waitcnt lgkmcnt(15)
    v_mfma_f32_16x16x32_bf16 v[128:131], v[200:203], v[80:83], v[128:131]
    ds_read_b64_tr_b16 v[56:57], v14 offset:0
    v_mfma_f32_16x16x32_bf16 v[132:135], v[204:207], v[80:83], v[132:135]
    ds_read_b64_tr_b16 v[58:59], v14 offset:4096
    v_mfma_f32_16x16x32_bf16 v[136:139], v[200:203], v[84:87], v[136:139]
    ds_read_b64_tr_b16 v[60:61], v15 offset:0
    v_mfma_f32_16x16x32_bf16 v[140:143], v[204:207], v[84:87], v[140:143]
    ds_read_b64_tr_b16 v[62:63], v15 offset:4096
    s_waitcnt lgkmcnt(15)
    v_mfma_f32_16x16x32_bf16 v[144:147], v[200:203], v[88:91], v[144:147]
    v_mfma_f32_16x16x32_bf16 v[148:151], v[204:207], v[88:91], v[148:151]
    v_mfma_f32_16x16x32_bf16 v[152:155], v[200:203], v[92:95], v[152:155]
    v_mfma_f32_16x16x32_bf16 v[156:159], v[204:207], v[92:95], v[156:159]
    s_waitcnt lgkmcnt(14)
    v_mfma_f32_16x16x32_bf16 v[248:251], v[32:35], v[32:35], v[248:251]
    ds_read_b64_tr_b16 v[64:65], v8 offset:8192
    v_mfma_f32_16x16x32_bf16 v[240:243], v[20:23], v[32:35], v[240:243]
    ds_read_b64_tr_b16 v[66:67], v8 offset:12288
    s_waitcnt lgkmcnt(14)
    v_mfma_f32_16x16x32_bf16 v[252:255], v[36:39], v[36:39], v[252:255]
    ds_read_b64_tr_b16 v[68:69], v9 offset:8192
    v_mfma_f32_16x16x32_bf16 v[244:247], v[20:23], v[36:39], v[244:247]
    ds_read_b64_tr_b16 v[70:71], v9 offset:12288
    s_waitcnt vmcnt(8)
    v_mfma_f32_16x16x32_bf16 v[96:99], v[208:211], v[32:35], v[96:99]
    ds_read_b64_tr_b16 v[72:73], v10 offset:8192
    v_mfma_f32_16x16x32_bf16 v[100:103], v[212:215], v[32:35], v[100:103]
    ds_read_b64_tr_b16 v[74:75], v10 offset:12288
    v_mfma_f32_16x16x32_bf16 v[104:107], v[208:211], v[36:39], v[104:107]
    ds_read_b64_tr_b16 v[76:77], v11 offset:8192
    v_mfma_f32_16x16x32_bf16 v[108:111], v[212:215], v[36:39], v[108:111]
    ds_read_b64_tr_b16 v[78:79], v11 offset:12288
    s_waitcnt lgkmcnt(15)
    v_mfma_f32_16x16x32_bf16 v[112:115], v[208:211], v[40:43], v[112:115]
    ds_read_b64_tr_b16 v[80:81], v12 offset:8192
    v_mfma_f32_16x16x32_bf16 v[116:119], v[212:215], v[40:43], v[116:119]
    ds_read_b64_tr_b16 v[82:83], v12 offset:12288
    v_mfma_f32_16x16x32_bf16 v[120:123], v[208:211], v[44:47], v[120:123]
    ds_read_b64_tr_b16 v[84:85], v13 offset:8192
    v_mfma_f32_16x16x32_bf16 v[124:127], v[212:215], v[44:47], v[124:127]
    ds_read_b64_tr_b16 v[86:87], v13 offset:12288
    s_waitcnt lgkmcnt(15)
    v_mfma_f32_16x16x32_bf16 v[128:131], v[208:211], v[48:51], v[128:131]
    ds_read_b64_tr_b16 v[88:89], v14 offset:8192
    v_mfma_f32_16x16x32_bf16 v[132:135], v[212:215], v[48:51], v[132:135]
    ds_read_b64_tr_b16 v[90:91], v14 offset:12288
    v_mfma_f32_16x16x32_bf16 v[136:139], v[208:211], v[52:55], v[136:139]
    ds_read_b64_tr_b16 v[92:93], v15 offset:8192
    v_mfma_f32_16x16x32_bf16 v[140:143], v[212:215], v[52:55], v[140:143]
    ds_read_b64_tr_b16 v[94:95], v15 offset:12288
    s_waitcnt lgkmcnt(15)
    v_mfma_f32_16x16x32_bf16 v[144:147], v[208:211], v[56:59], v[144:147]
    v_mfma_f32_16x16x32_bf16 v[148:151], v[212:215], v[56:59], v[148:151]
    v_mfma_f32_16x16x32_bf16 v[152:155], v[208:211], v[60:63], v[152:155]
    v_mfma_f32_16x16x32_bf16 v[156:159], v[212:215], v[60:63], v[156:159]
    s_waitcnt lgkmcnt(14)
    v_mfma_f32_16x16x32_bf16 v[248:251], v[64:67], v[64:67], v[248:251]
    ds_read_b64_tr_b16 v[32:33], v8 offset:16384
    v_mfma_f32_16x16x32_bf16 v[240:243], v[20:23], v[64:67], v[240:243]
    ds_read_b64_tr_b16 v[34:35], v8 offset:20480
    s_waitcnt lgkmcnt(14)
    v_mfma_f32_16x16x32_bf16 v[252:255], v[68:71], v[68:71], v[252:255]
    ds_read_b64_tr_b16 v[36:37], v9 offset:16384
    v_mfma_f32_16x16x32_bf16 v[244:247], v[20:23], v[68:71], v[244:247]
    ds_read_b64_tr_b16 v[38:39], v9 offset:20480
    s_waitcnt vmcnt(6)
    v_mfma_f32_16x16x32_bf16 v[96:99], v[216:219], v[64:67], v[96:99]
    ds_read_b64_tr_b16 v[40:41], v10 offset:16384
    v_mfma_f32_16x16x32_bf16 v[100:103], v[220:223], v[64:67], v[100:103]
    ds_read_b64_tr_b16 v[42:43], v10 offset:20480
    v_mfma_f32_16x16x32_bf16 v[104:107], v[216:219], v[68:71], v[104:107]
    ds_read_b64_tr_b16 v[44:45], v11 offset:16384
    v_mfma_f32_16x16x32_bf16 v[108:111], v[220:223], v[68:71], v[108:111]
    ds_read_b64_tr_b16 v[46:47], v11 offset:20480
    s_waitcnt lgkmcnt(15)
    v_mfma_f32_16x16x32_bf16 v[112:115], v[216:219], v[72:75], v[112:115]
    ds_read_b64_tr_b16 v[48:49], v12 offset:16384
    v_mfma_f32_16x16x32_bf16 v[116:119], v[220:223], v[72:75], v[116:119]
    ds_read_b64_tr_b16 v[50:51], v12 offset:20480
    v_mfma_f32_16x16x32_bf16 v[120:123], v[216:219], v[76:79], v[120:123]
    ds_read_b64_tr_b16 v[52:53], v13 offset:16384
    v_mfma_f32_16x16x32_bf16 v[124:127], v[220:223], v[76:79], v[124:127]
    ds_read_b64_tr_b16 v[54:55], v13 offset:20480
    s_waitcnt lgkmcnt(15)
    v_mfma_f32_16x16x32_bf16 v[128:131], v[216:219], v[80:83], v[128:131]
    ds_read_b64_tr_b16 v[56:57], v14 offset:16384
    v_mfma_f32_16x16x32_bf16 v[132:135], v[220:223], v[80:83], v[132:135]
    ds_read_b64_tr_b16 v[58:59], v14 offset:20480
    v_mfma_f32_16x16x32_bf16 v[136:139], v[216:219], v[84:87], v[136:139]
    ds_read_b64_tr_b16 v[60:61], v15 offset:16384
    v_mfma_f32_16x16x32_bf16 v[140:143], v[220:223], v[84:87], v[140:143]
    ds_read_b64_tr_b16 v[62:63], v15 offset:20480
    s_waitcnt lgkmcnt(15)
    v_mfma_f32_16x16x32_bf16 v[144:147], v[216:219], v[88:91], v[144:147]
    v_mfma_f32_16x16x32_bf16 v[148:151], v[220:223], v[88:91], v[148:151]
    v_mfma_f32_16x16x32_bf16 v[152:155], v[216:219], v[92:95], v[152:155]
    v_mfma_f32_16x16x32_bf16 v[156:159], v[220:223], v[92:95], v[156:159]
    s_waitcnt lgkmcnt(14)
    v_mfma_f32_16x16x32_bf16 v[248:251], v[32:35], v[32:35], v[248:251]
    ds_read_b64_tr_b16 v[64:65], v8 offset:24576
    v_mfma_f32_16x16x32_bf16 v[240:243], v[20:23], v[32:35], v[240:243]
    ds_read_b64_tr_b16 v[66:67], v8 offset:28672
    s_waitcnt lgkmcnt(14)
    v_mfma_f32_16x16x32_bf16 v[252:255], v[36:39], v[36:39], v[252:255]
    ds_read_b64_tr_b16 v[68:69], v9 offset:24576
    v_mfma_f32_16x16x32_bf16 v[244:247], v[20:23], v[36:39], v[244:247]
    ds_read_b64_tr_b16 v[70:71], v9 offset:28672
    s_waitcnt vmcnt(4)
    v_mfma_f32_16x16x32_bf16 v[96:99], v[224:227], v[32:35], v[96:99]
    ds_read_b64_tr_b16 v[72:73], v10 offset:24576
    v_mfma_f32_16x16x32_bf16 v[100:103], v[228:231], v[32:35], v[100:103]
    ds_read_b64_tr_b16 v[74:75], v10 offset:28672
    v_mfma_f32_16x16x32_bf16 v[104:107], v[224:227], v[36:39], v[104:107]
    ds_read_b64_tr_b16 v[76:77], v11 offset:24576
    v_mfma_f32_16x16x32_bf16 v[108:111], v[228:231], v[36:39], v[108:111]
    ds_read_b64_tr_b16 v[78:79], v11 offset:28672
    s_waitcnt lgkmcnt(15)
    v_mfma_f32_16x16x32_bf16 v[112:115], v[224:227], v[40:43], v[112:115]
    ds_read_b64_tr_b16 v[80:81], v12 offset:24576
    v_mfma_f32_16x16x32_bf16 v[116:119], v[228:231], v[40:43], v[116:119]
    ds_read_b64_tr_b16 v[82:83], v12 offset:28672
    v_mfma_f32_16x16x32_bf16 v[120:123], v[224:227], v[44:47], v[120:123]
    ds_read_b64_tr_b16 v[84:85], v13 offset:24576
    v_mfma_f32_16x16x32_bf16 v[124:127], v[228:231], v[44:47], v[124:127]
    ds_read_b64_tr_b16 v[86:87], v13 offset:28672
    s_waitcnt lgkmcnt(15)
    v_mfma_f32_16x16x32_bf16 v[128:131], v[224:227], v[48:51], v[128:131]
    ds_read_b64_tr_b16 v[88:89], v14 offset:24576
    v_mfma_f32_16x16x32_bf16 v[132:135], v[228:231], v[48:51], v[132:135]
    ds_read_b64_tr_b16 v[90:91], v14 offset:28672
    v_mfma_f32_16x16x32_bf16 v[136:139], v[224:227], v[52:55], v[136:139]
    ds_read_b64_tr_b16 v[92:93], v15 offset:24576
    v_mfma_f32_16x16x32_bf16 v[140:143], v[228:231], v[52:55], v[140:143]
    ds_read_b64_tr_b16 v[94:95], v15 offset:28672
    s_waitcnt lgkmcnt(15)
    v_mfma_f32_16x16x32_bf16 v[144:147], v[224:227], v[56:59], v[144:147]
    v_mfma_f32_16x16x32_bf16 v[148:151], v[228:231], v[56:59], v[148:151]
    v_mfma_f32_16x16x32_bf16 v[152:155], v[224:227], v[60:63], v[152:155]
    v_mfma_f32_16x16x32_bf16 v[156:159], v[228:231], v[60:63], v[156:159]
    s_waitcnt lgkmcnt(14)
    v_mfma_f32_16x16x32_bf16 v[248:251], v[64:67], v[64:67], v[248:251]
    v_mfma_f32_16x16x32_bf16 v[240:243], v[20:23], v[64:67], v[240:243]
    s_waitcnt lgkmcnt(12)
    v_mfma_f32_16x16x32_bf16 v[252:255], v[68:71], v[68:71], v[252:255]
    v_mfma_f32_16x16x32_bf16 v[244:247], v[20:23], v[68:71], v[244:247]
    s_waitcnt vmcnt(2)
    v_mfma_f32_16x16x32_bf16 v[96:99], v[232:235], v[64:67], v[96:99]
    v_mfma_f32_16x16x32_bf16 v[100:103], v[236:239], v[64:67], v[100:103]
    v_mfma_f32_16x16x32_bf16 v[104:107], v[232:235], v[68:71], v[104:107]
    v_mfma_f32_16x16x32_bf16 v[108:111], v[236:239], v[68:71], v[108:111]
    v_cndmask_b32 v248, v248, v249, s[40:41]
    v_cndmask_b32 v248, v248, v250, s[42:43]
    v_cndmask_b32 v248, v248, v251, s[46:47]
    v_cndmask_b32 v248, 0, v248, s[50:51]
    s_waitcnt lgkmcnt(10)
    v_mfma_f32_16x16x32_bf16 v[112:115], v[232:235], v[72:75], v[112:115]
    v_cndmask_b32 v252, v252, v253, s[40:41]
    v_cndmask_b32 v252, v252, v254, s[42:43]
    v_cndmask_b32 v252, v252, v255, s[46:47]
    v_cndmask_b32 v252, 0, v252, s[50:51]
    v_mfma_f32_16x16x32_bf16 v[116:119], v[236:239], v[72:75], v[116:119]
    v_cndmask_b32 v24, v240, v244, s[48:49]
    s_nop 0
    v_permlane16_swap_b32 v248, v252
    s_nop 1
    s_waitcnt lgkmcnt(8)
    v_mfma_f32_16x16x32_bf16 v[120:123], v[232:235], v[76:79], v[120:123]
    v_add_f32 v25, v248, v252
    v_mov_b32 v26, v25
    s_nop 1
    v_permlane32_swap_b32 v25, v26
    v_mfma_f32_16x16x32_bf16 v[124:127], v[236:239], v[76:79], v[124:127]
    s_nop 1
    v_add_f32 v25, v25, v26
    s_mov_b32 s24, 986500301
    v_mul_f32 v24, s24, v24
    s_waitcnt lgkmcnt(6)
    v_mfma_f32_16x16x32_bf16 v[128:131], v[232:235], v[80:83], v[128:131]
    v_mul_f32 v25, s24, v25
    v_fma_f32 v25, -v24, v24, v25
    v_max_f32 v25, 0, v25
    v_cvt_pk_bf16_f32 v26, v24, v25
    v_mfma_f32_16x16x32_bf16 v[132:135], v[236:239], v[80:83], v[132:135]
    v_lshlrev_b32 v24, 16, v26
    v_and_b32 v25, s23, v26
    v_add_f32 v25, 925353388, v25
    v_cvt_pk_bf16_f32 v25, v25, v25
    s_waitcnt lgkmcnt(4)
    v_mfma_f32_16x16x32_bf16 v[136:139], v[232:235], v[84:87], v[136:139]
    v_lshlrev_b32 v25, 16, v25
    v_sqrt_f32 v25, v25
    s_nop 0
    v_cvt_pk_bf16_f32 v25, v25, v25
    v_mfma_f32_16x16x32_bf16 v[140:143], v[236:239], v[84:87], v[140:143]
    v_lshlrev_b32 v25, 16, v25
    v_rcp_f32 v26, v25
    v_xor_b32 v24, 0x80000000, v24
    v_cndmask_b32 v24, v24, v25, s[44:45]
    s_waitcnt lgkmcnt(2)
    v_mfma_f32_16x16x32_bf16 v[144:147], v[232:235], v[88:91], v[144:147]
    v_lshrrev_b32 v25, 16, v24
    v_or_b32 v24, v24, v25
    v_mov_b32 v25, v24
    ds_write_b128 v18, v[24:27]
    v_mfma_f32_16x16x32_bf16 v[148:151], v[236:239], v[88:91], v[148:151]
    ds_write_b128 v19, v[24:27]
    s_waitcnt lgkmcnt(0)
    v_mfma_f32_16x16x32_bf16 v[152:155], v[232:235], v[92:95], v[152:155]
    v_mfma_f32_16x16x32_bf16 v[156:159], v[236:239], v[92:95], v[156:159]
    s_mov_b32 s30, 0
g1_stat:
    ds_read_b128 v[32:35], v17 offset:0
    ds_read_b128 v[36:39], v17 offset:256
    ds_read_b128 v[40:43], v17 offset:512
    ds_read_b128 v[44:47], v17 offset:768
    ds_read_b128 v[48:51], v17 offset:1024
    ds_read_b128 v[52:55], v17 offset:1280
    ds_read_b128 v[56:59], v17 offset:1536
    ds_read_b128 v[60:63], v17 offset:1792
    s_add_u32 s30, s30, 1
    s_waitcnt lgkmcnt(4)
    v_and_b32 v24, v35, v39
    v_and_b32 v25, v43, v47
    s_waitcnt lgkmcnt(0)
    v_and_b32 v26, v51, v55
    v_and_b32 v27, v59, v63
    v_and_b32 v24, v24, v25
    v_and_b32 v26, v26, v27
    v_and_b32 v24, v24, v26
    v_cmp_eq_u32 vcc, 0, v24
    s_cmp_eq_u64 vcc, 0
    s_cbranch_scc1 g1_statok
    s_cmp_lt_u32 s30, 32768
    s_cbranch_scc1 g1_stat
g1_statok:
    s_waitcnt vmcnt(0)
    v_mfma_f32_16x16x16_bf16 v[96:99], v[160:161], v[32:33], v[96:99]
    v_mfma_f32_16x16x16_bf16 v[100:103], v[164:165], v[32:33], v[100:103]
    v_mfma_f32_16x16x16_bf16 v[104:107], v[160:161], v[36:37], v[104:107]
    v_mfma_f32_16x16x16_bf16 v[108:111], v[164:165], v[36:37], v[108:111]
    v_mfma_f32_16x16x16_bf16 v[112:115], v[160:161], v[40:41], v[112:115]
    v_mfma_f32_16x16x16_bf16 v[116:119], v[164:165], v[40:41], v[116:119]
    s_setprio 2
    s_nop 1
    v_pk_mul_f32 v[96:97], v[96:97], v[34:35] op_sel_hi:[1,0]
    v_pk_mul_f32 v[98:99], v[98:99], v[34:35] op_sel_hi:[1,0]
    v_pk_mul_f32 v[100:101], v[100:101], v[34:35] op_sel_hi:[1,0]
    v_pk_mul_f32 v[102:103], v[102:103], v[34:35] op_sel_hi:[1,0]
    v_mfma_f32_16x16x16_bf16 v[120:123], v[160:161], v[44:45], v[120:123]
    v_cvt_pk_bf16_f32 v176, v96, v97
    v_cvt_pk_bf16_f32 v177, v98, v99
    v_cvt_pk_bf16_f32 v178, v100, v101
    v_cvt_pk_bf16_f32 v179, v102, v103
    v_mfma_f32_16x16x16_bf16 v[124:127], v[164:165], v[44:45], v[124:127]
    v_pk_max_i16 v176, v176, 0
    v_pk_max_i16 v177, v177, 0
    v_pk_max_i16 v178, v178, 0
    v_pk_max_i16 v179, v179, 0
    buffer_store_dwordx4 v[176:179], v16, s[36:39], s3 offen sc0 sc1
    v_pk_mul_f32 v[104:105], v[104:105], v[38:39] op_sel_hi:[1,0]
    v_pk_mul_f32 v[106:107], v[106:107], v[38:39] op_sel_hi:[1,0]
    v_pk_mul_f32 v[108:109], v[108:109], v[38:39] op_sel_hi:[1,0]
    v_pk_mul_f32 v[110:111], v[110:111], v[38:39] op_sel_hi:[1,0]
    v_mfma_f32_16x16x16_bf16 v[128:131], v[160:161], v[48:49], v[128:131]
    v_cvt_pk_bf16_f32 v180, v104, v105
    v_cvt_pk_bf16_f32 v181, v106, v107
    v_cvt_pk_bf16_f32 v182, v108, v109
    v_cvt_pk_bf16_f32 v183, v110, v111
    v_mfma_f32_16x16x16_bf16 v[132:135], v[164:165], v[48:49], v[132:135]
    v_pk_max_i16 v180, v180, 0
    v_pk_max_i16 v181, v181, 0
    v_pk_max_i16 v182, v182, 0
    v_pk_max_i16 v183, v183, 0
    buffer_store_dwordx4 v[180:183], v16, s[36:39], s4 offen sc0 sc1
    v_pk_mul_f32 v[112:113], v[112:113], v[42:43] op_sel_hi:[1,0]
    v_pk_mul_f32 v[114:115], v[114:115], v[42:43] op_sel_hi:[1,0]
    v_pk_mul_f32 v[116:117], v[116:117], v[42:43] op_sel_hi:[1,0]
    v_pk_mul_f32 v[118:119], v[118:119], v[42:43] op_sel_hi:[1,0]
    v_mfma_f32_16x16x16_bf16 v[136:139], v[160:161], v[52:53], v[136:139]
    v_cvt_pk_bf16_f32 v184, v112, v113
    v_cvt_pk_bf16_f32 v185, v114, v115
    v_cvt_pk_bf16_f32 v186, v116, v117
    v_cvt_pk_bf16_f32 v187, v118, v119
    v_mfma_f32_16x16x16_bf16 v[140:143], v[164:165], v[52:53], v[140:143]
    v_pk_max_i16 v184, v184, 0
    v_pk_max_i16 v185, v185, 0
    v_pk_max_i16 v186, v186, 0
    v_pk_max_i16 v187, v187, 0
    buffer_store_dwordx4 v[184:187], v16, s[36:39], s5 offen sc0 sc1
    v_pk_mul_f32 v[120:121], v[120:121], v[46:47] op_sel_hi:[1,0]
    v_pk_mul_f32 v[122:123], v[122:123], v[46:47] op_sel_hi:[1,0]
    v_pk_mul_f32 v[124:125], v[124:125], v[46:47] op_sel_hi:[1,0]
    v_pk_mul_f32 v[126:127], v[126:127], v[46:47] op_sel_hi:[1,0]
    v_mfma_f32_16x16x16_bf16 v[144:147], v[160:161], v[56:57], v[144:147]
    v_cvt_pk_bf16_f32 v188, v120, v121
    v_cvt_pk_bf16_f32 v189, v122, v123
    v_cvt_pk_bf16_f32 v190, v124, v125
    v_cvt_pk_bf16_f32 v191, v126, v127
    v_mfma_f32_16x16x16_bf16 v[148:151], v[164:165], v[56:57], v[148:151]
    v_pk_max_i16 v188, v188, 0
    v_pk_max_i16 v189, v189, 0
    v_pk_max_i16 v190, v190, 0
    v_pk_max_i16 v191, v191, 0
    buffer_store_dwordx4 v[188:191], v16, s[36:39], s6 offen sc0 sc1
    v_pk_mul_f32 v[128:129], v[128:129], v[50:51] op_sel_hi:[1,0]
    v_pk_mul_f32 v[130:131], v[130:131], v[50:51] op_sel_hi:[1,0]
    v_pk_mul_f32 v[132:133], v[132:133], v[50:51] op_sel_hi:[1,0]
    v_pk_mul_f32 v[134:135], v[134:135], v[50:51] op_sel_hi:[1,0]
    v_mfma_f32_16x16x16_bf16 v[152:155], v[160:161], v[60:61], v[152:155]
    v_cvt_pk_bf16_f32 v192, v128, v129
    v_cvt_pk_bf16_f32 v193, v130, v131
    v_cvt_pk_bf16_f32 v194, v132, v133
    v_cvt_pk_bf16_f32 v195, v134, v135
    v_mfma_f32_16x16x16_bf16 v[156:159], v[164:165], v[60:61], v[156:159]
    v_pk_max_i16 v192, v192, 0
    v_pk_max_i16 v193, v193, 0
    v_pk_max_i16 v194, v194, 0
    v_pk_max_i16 v195, v195, 0
    buffer_store_dwordx4 v[192:195], v16, s[36:39], s7 offen sc0 sc1
    v_pk_mul_f32 v[136:137], v[136:137], v[54:55] op_sel_hi:[1,0]
    v_pk_mul_f32 v[138:139], v[138:139], v[54:55] op_sel_hi:[1,0]
    v_pk_mul_f32 v[140:141], v[140:141], v[54:55] op_sel_hi:[1,0]
    v_pk_mul_f32 v[142:143], v[142:143], v[54:55] op_sel_hi:[1,0]
    v_cvt_pk_bf16_f32 v196, v136, v137
    v_cvt_pk_bf16_f32 v197, v138, v139
    v_cvt_pk_bf16_f32 v198, v140, v141
    v_cvt_pk_bf16_f32 v199, v142, v143
    v_pk_max_i16 v196, v196, 0
    v_pk_max_i16 v197, v197, 0
    v_pk_max_i16 v198, v198, 0
    v_pk_max_i16 v199, v199, 0
    buffer_store_dwordx4 v[196:199], v16, s[36:39], s8 offen sc0 sc1
    v_pk_mul_f32 v[144:145], v[144:145], v[58:59] op_sel_hi:[1,0]
    v_pk_mul_f32 v[146:147], v[146:147], v[58:59] op_sel_hi:[1,0]
    v_pk_mul_f32 v[148:149], v[148:149], v[58:59] op_sel_hi:[1,0]
    v_pk_mul_f32 v[150:151], v[150:151], v[58:59] op_sel_hi:[1,0]
    v_cvt_pk_bf16_f32 v200, v144, v145
    v_cvt_pk_bf16_f32 v201, v146, v147
    v_cvt_pk_bf16_f32 v202, v148, v149
    v_cvt_pk_bf16_f32 v203, v150, v151
    v_pk_max_i16 v200, v200, 0
    v_pk_max_i16 v201, v201, 0
    v_pk_max_i16 v202, v202, 0
    v_pk_max_i16 v203, v203, 0
    buffer_store_dwordx4 v[200:203], v16, s[36:39], s9 offen sc0 sc1
    v_pk_mul_f32 v[152:153], v[152:153], v[62:63] op_sel_hi:[1,0]
    v_pk_mul_f32 v[154:155], v[154:155], v[62:63] op_sel_hi:[1,0]
    v_pk_mul_f32 v[156:157], v[156:157], v[62:63] op_sel_hi:[1,0]
    v_pk_mul_f32 v[158:159], v[158:159], v[62:63] op_sel_hi:[1,0]
    v_cvt_pk_bf16_f32 v204, v152, v153
    v_cvt_pk_bf16_f32 v205, v154, v155
    v_cvt_pk_bf16_f32 v206, v156, v157
    v_cvt_pk_bf16_f32 v207, v158, v159
    v_pk_max_i16 v204, v204, 0
    v_pk_max_i16 v205, v205, 0
    v_pk_max_i16 v206, v206, 0
    v_pk_max_i16 v207, v207, 0
    buffer_store_dwordx4 v[204:207], v16, s[36:39], s12 offen sc0 sc1
    s_setprio 0
    v_and_b32 v1, 63, v0
    v_lshlrev_b32 v1, 4, v1
    s_mul_i32 s88, s54, 40960
    v_add_u32 v4, s88, v1
    s_lshl_b32 s88, s54, 11
    v_add_u32 v8, s88, v1
    v_add_u32 v9, 0x10000, v8
    v_add_u32 v10, 0x20000, v8
    v_lshlrev_b32 v12, 7, v1
    s_lshl_b32 s22, s20, 4
    s_add_u32 s22, s22, s21
    s_lshl_b32 s22, s22, 3
    v_mov_b32 v14, s56
    v_mov_b32 v15, s57
    v_mov_b32 v16, 139248
    v_mov_b32 v17, 1
    s_mov_b64 exec, 1
    s_waitcnt vmcnt(0)
    ds_add_rtn_u32 v17, v16, v17
    s_waitcnt lgkmcnt(0)
    v_readfirstlane_b32 s23, v17
    s_mov_b32 exec_lo, 0xffffffff
    s_mov_b32 exec_hi, 0
    s_cmp_lg_u32 s23, 3
    s_cbranch_scc1 g1_noflag
    buffer_store_dwordx2 v[14:15], v12, s[80:83], s22 offen sc1
g1_noflag:
    s_mov_b64 exec, -1
    s_barrier
    s_add_u32 s88, s76, 44032
    buffer_load_dwordx4 v[208:211], v1, s[60:63], s88 offen offset:0
    buffer_load_dwordx4 v[212:215], v1, s[60:63], s88 offen offset:1024
    s_add_u32 s88, s76, 49152
    buffer_load_dwordx4 v[216:219], v1, s[60:63], s88 offen offset:0
    buffer_load_dwordx4 v[220:223], v1, s[60:63], s88 offen offset:1024
    s_add_u32 s88, s76, 54272
    buffer_load_dwordx4 v[224:227], v1, s[60:63], s88 offen offset:0
    buffer_load_dwordx4 v[228:231], v1, s[60:63], s88 offen offset:1024
    ds_read_b128 v[144:147], v10 offset:8192
    ds_read_b128 v[148:151], v10 offset:9216
    ds_read_b128 v[152:155], v10 offset:16384
    ds_read_b128 v[156:159], v10 offset:17408
    ds_read_b128 v[160:163], v10 offset:24576
    ds_read_b128 v[164:167], v10 offset:25600
    ds_read_b128 v[168:171], v8 offset:32768
    ds_read_b128 v[172:175], v8 offset:33792
    ds_read_b128 v[176:179], v8 offset:40960
    ds_read_b128 v[180:183], v8 offset:41984
    ds_read_b128 v[184:187], v8 offset:49152
    ds_read_b128 v[188:191], v8 offset:50176
    ds_read_b128 v[192:195], v8 offset:57344
    ds_read_b128 v[196:199], v8 offset:58368
    ds_read_b128 v[200:203], v9 offset:0
    ds_read_b128 v[204:207], v9 offset:1024
    s_waitcnt lgkmcnt(0)
    s_branch g2_cwait
g1_cidle:
    s_waitcnt lgkmcnt(0)
    s_load_dwordx2 s[10:11], s[0:1], 112
    s_and_b32 s54, s26, 3
    s_lshr_b32 s55, s26, 2
    s_add_u32 s60, s14, 21348352
    s_addc_u32 s61, s15, 0
    s_mov_b32 s62, 2211840
    s_mov_b32 s63, 0x00020000
    s_add_u32 s64, s14, 21348352
    s_addc_u32 s65, s15, 0
    s_mov_b32 s66, 2211840
    s_mov_b32 s67, 0x00020000
    s_add_u32 s68, s14, 13828096
    s_addc_u32 s69, s15, 0
    s_mov_b32 s70, 7077888
    s_mov_b32 s71, 0x00020000
    s_add_u32 s72, s14, 13828096
    s_addc_u32 s73, s15, 0
    s_mov_b32 s74, 7077888
    s_mov_b32 s75, 0x00020000
    s_cmp_lt_u32 s54, 2
    s_cselect_b32 s66, s66, 0
    s_cselect_b32 s74, s74, 0
    s_mul_i32 s88, s54, 14
    s_cmp_eq_u32 s54, 3
    s_subb_u32 s88, s88, 0
    s_mul_i32 s76, s53, 54
    s_add_u32 s76, s76, s88
    s_mul_i32 s76, s76, 5120
    s_lshl_b32 s89, s55, 1
    s_add_u32 s89, s89, s54
    s_and_b32 s89, s89, 3
    s_lshl_b32 s90, s52, 2
    s_add_u32 s89, s89, s90
    s_mul_i32 s89, s89, 54
    s_add_u32 s89, s89, s88
    s_lshl_b32 s77, s89, 10
    s_lshl_b32 s89, s55, 1
    s_add_u32 s89, s89, s54
    s_add_u32 s89, s89, 1
    s_and_b32 s89, s89, 3
    s_lshl_b32 s90, s52, 2
    s_add_u32 s89, s89, s90
    s_mul_i32 s89, s89, 54
    s_add_u32 s89, s89, s88
    s_lshl_b32 s78, s89, 10
    s_lshl_b32 s79, s54, 1
    s_add_u32 s79, s79, s55
    s_mul_i32 s79, s79, 20480
    v_and_b32 v1, 63, v0
    v_lshlrev_b32 v1, 4, v1
    s_mul_i32 s88, s54, 40960
    v_add_u32 v4, s88, v1
    s_add_u32 s88, s76, 3072
    buffer_load_dwordx4 v[144:147], v1, s[60:63], s88 offen offset:0
    buffer_load_dwordx4 v[148:151], v1, s[60:63], s88 offen offset:1024
    s_add_u32 s88, s76, 8192
    buffer_load_dwordx4 v[152:155], v1, s[60:63], s88 offen offset:0
    buffer_load_dwordx4 v[156:159], v1, s[60:63], s88 offen offset:1024
    s_add_u32 s88, s76, 13312
    buffer_load_dwordx4 v[160:163], v1, s[60:63], s88 offen offset:0
    buffer_load_dwordx4 v[164:167], v1, s[60:63], s88 offen offset:1024
    s_add_u32 s88, s76, 18432
    buffer_load_dwordx4 v[168:171], v1, s[60:63], s88 offen offset:0
    buffer_load_dwordx4 v[172:175], v1, s[60:63], s88 offen offset:1024
    s_add_u32 s88, s76, 23552
    buffer_load_dwordx4 v[176:179], v1, s[60:63], s88 offen offset:0
    buffer_load_dwordx4 v[180:183], v1, s[60:63], s88 offen offset:1024
    s_add_u32 s88, s76, 28672
    buffer_load_dwordx4 v[184:187], v1, s[60:63], s88 offen offset:0
    buffer_load_dwordx4 v[188:191], v1, s[60:63], s88 offen offset:1024
    s_add_u32 s88, s76, 33792
    buffer_load_dwordx4 v[192:195], v1, s[60:63], s88 offen offset:0
    buffer_load_dwordx4 v[196:199], v1, s[60:63], s88 offen offset:1024
    s_add_u32 s88, s76, 38912
    buffer_load_dwordx4 v[200:203], v1, s[60:63], s88 offen offset:0
    buffer_load_dwordx4 v[204:207], v1, s[60:63], s88 offen offset:1024
    s_add_u32 s88, s76, 44032
    buffer_load_dwordx4 v[208:211], v1, s[60:63], s88 offen offset:0
    buffer_load_dwordx4 v[212:215], v1, s[60:63], s88 offen offset:1024
    s_add_u32 s88, s76, 49152
    buffer_load_dwordx4 v[216:219], v1, s[60:63], s88 offen offset:0
    buffer_load_dwordx4 v[220:223], v1, s[60:63], s88 offen offset:1024
    s_add_u32 s88, s76, 54272
    buffer_load_dwordx4 v[224:227], v1, s[60:63], s88 offen offset:0
    buffer_load_dwordx4 v[228:231], v1, s[60:63], s88 offen offset:1024
g2_cwait:
    s_barrier
    s_add_u32 m0, s79, 0
    s_add_u32 s88, s77, 0
    buffer_load_dwordx4 v1, s[68:71], s88 offen sc1 lds
    s_add_u32 m0, s79, 10240
    s_add_u32 s88, s78, 0
    buffer_load_dwordx4 v1, s[68:71], s88 offen sc1 lds
    s_add_u32 m0, s79, 1024
    s_add_u32 s88, s77, 1024
    buffer_load_dwordx4 v1, s[68:71], s88 offen sc1 lds
    s_add_u32 m0, s79, 11264
    s_add_u32 s88, s78, 1024
    buffer_load_dwordx4 v1, s[68:71], s88 offen sc1 lds
    s_add_u32 m0, s79, 2048
    s_add_u32 s88, s77, 2048
    buffer_load_dwordx4 v1, s[68:71], s88 offen sc1 lds
    s_add_u32 m0, s79, 12288
    s_add_u32 s88, s78, 2048
    buffer_load_dwordx4 v1, s[68:71], s88 offen sc1 lds
    s_add_u32 m0, s79, 3072
    s_add_u32 s88, s77, 3072
    buffer_load_dwordx4 v1, s[68:71], s88 offen sc1 lds
    s_add_u32 m0, s79, 13312
    s_add_u32 s88, s78, 3072
    buffer_load_dwordx4 v1, s[68:71], s88 offen sc1 lds
    s_add_u32 m0, s79, 4096
    s_add_u32 s88, s77, 4096
    buffer_load_dwordx4 v1, s[68:71], s88 offen sc1 lds
    s_add_u32 m0, s79, 14336
    s_add_u32 s88, s78, 4096
    buffer_load_dwordx4 v1, s[68:71], s88 offen sc1 lds
    s_add_u32 s28, s14, 8257536
    s_addc_u32 s29, s15, 0
    s_mov_b32 s30, 2785280
    s_mov_b32 s31, 0x00020000
    s_mov_b32 s32, s14
    s_mov_b32 s33, s15
    s_mov_b32 s34, 15360
    s_mov_b32 s35, 0x00020000
    s_waitcnt lgkmcnt(0)
    s_mov_b32 s36, s10
    s_mov_b32 s37, s11
    s_mov_b32 s38, 2621440
    s_mov_b32 s39, 0x00020000
    v_lshrrev_b32 v5, 8, v1
    v_bfe_u32 v6, v1, 4, 4
    s_lshl_b32 s20, s52, 2
    s_add_u32 s20, s20, s54
    s_lshl_b32 s20, s20, 4
    s_mul_i32 s21, s53, 80
    s_add_u32 s21, s21, 48
    v_lshlrev_b32 v3, 4, v5
    v_lshrrev_b32 v2, 5, v1
    v_mul_u32_u24 v2, 4352, v2
    v_and_b32 v7, 16, v1
    v_add_u32 v2, v2, v7
    s_mul_i32 s26, s54, 40960
    s_mul_i32 s22, s21, 4352
    s_lshl_b32 s23, s20, 1
    s_add_u32 s22, s22, s23
    s_lshl_b32 s23, s21, 2
    s_add_u32 s23, s23, 12800
    s_mul_i32 s24, s20, 1280
    s_lshl_b32 s25, s21, 1
    s_add_u32 s24, s24, s25
    v_mul_u32_u24 v7, 1280, v6
    v_lshl_add_u32 v6, v5, 4, v7
    v_lshl_add_u32 v7, v5, 3, v7
    v_lshrrev_b32 v5, 1, v1
    v_sub_u32 v5, v4, v5
    s_waitcnt vmcnt(8)
    s_barrier
    ds_read_b128 v[12:15], v4 offset:10240
    ds_read_b128 v[16:19], v4 offset:20480
    ds_read_b128 v[20:23], v4 offset:30720
    ds_read_b128 v[8:11], v4 offset:0
    s_waitcnt lgkmcnt(3)
    v_mfma_f32_16x16x32_bf16 v[48:51], v[144:147], v[12:15], 0
    s_add_u32 m0, s79, 5120
    s_add_u32 s88, s77, 5120
    buffer_load_dwordx4 v1, s[68:71], s88 offen sc1 lds
    v_mfma_f32_16x16x32_bf16 v[52:55], v[148:151], v[12:15], 0
    s_add_u32 m0, s79, 15360
    s_add_u32 s88, s78, 5120
    buffer_load_dwordx4 v1, s[68:71], s88 offen sc1 lds
    s_waitcnt lgkmcnt(2)
    v_mfma_f32_16x16x32_bf16 v[56:59], v[144:147], v[16:19], 0
    v_mfma_f32_16x16x32_bf16 v[60:63], v[148:151], v[16:19], 0
    s_waitcnt vmcnt(8)
    s_barrier
    s_waitcnt lgkmcnt(1)
    v_mfma_f32_16x16x32_bf16 v[64:67], v[144:147], v[20:23], 0
    ds_read_b128 v[28:31], v4 offset:11264
    v_mfma_f32_16x16x32_bf16 v[68:71], v[148:151], v[20:23], 0
    ds_read_b128 v[32:35], v4 offset:21504
    s_waitcnt lgkmcnt(2)
    v_mfma_f32_16x16x32_bf16 v[40:43], v[144:147], v[8:11], 0
    ds_read_b128 v[36:39], v4 offset:31744
    v_mfma_f32_16x16x32_bf16 v[44:47], v[148:151], v[8:11], 0
    ds_read_b128 v[24:27], v4 offset:1024
    s_waitcnt lgkmcnt(3)
    v_mfma_f32_16x16x32_bf16 v[48:51], v[152:155], v[28:31], v[48:51]
    s_add_u32 m0, s79, 6144
    s_add_u32 s88, s77, 6144
    buffer_load_dwordx4 v1, s[68:71], s88 offen sc1 lds
    v_mfma_f32_16x16x32_bf16 v[52:55], v[156:159], v[28:31], v[52:55]
    s_add_u32 m0, s79, 16384
    s_add_u32 s88, s78, 6144
    buffer_load_dwordx4 v1, s[68:71], s88 offen sc1 lds
    s_waitcnt lgkmcnt(2)
    v_mfma_f32_16x16x32_bf16 v[56:59], v[152:155], v[32:35], v[56:59]
    v_mfma_f32_16x16x32_bf16 v[60:63], v[156:159], v[32:35], v[60:63]
    s_waitcnt vmcnt(8)
    s_barrier
    s_waitcnt lgkmcnt(1)
    v_mfma_f32_16x16x32_bf16 v[64:67], v[152:155], v[36:39], v[64:67]
    ds_read_b128 v[12:15], v4 offset:12288
    v_mfma_f32_16x16x32_bf16 v[68:71], v[156:159], v[36:39], v[68:71]
    ds_read_b128 v[16:19], v4 offset:22528
    s_waitcnt lgkmcnt(2)
    v_mfma_f32_16x16x32_bf16 v[40:43], v[152:155], v[24:27], v[40:43]
    ds_read_b128 v[20:23], v4 offset:32768
    v_mfma_f32_16x16x32_bf16 v[44:47], v[156:159], v[24:27], v[44:47]
    ds_read_b128 v[8:11], v4 offset:2048
    s_waitcnt lgkmcnt(3)
    v_mfma_f32_16x16x32_bf16 v[48:51], v[160:163], v[12:15], v[48:51]
    s_add_u32 m0, s79, 7168
    s_add_u32 s88, s77, 7168
    buffer_load_dwordx4 v1, s[68:71], s88 offen sc1 lds
    v_mfma_f32_16x16x32_bf16 v[52:55], v[164:167], v[12:15], v[52:55]
    s_add_u32 m0, s79, 17408
    s_add_u32 s88, s78, 7168
    buffer_load_dwordx4 v1, s[68:71], s88 offen sc1 lds
    s_waitcnt lgkmcnt(2)
    v_mfma_f32_16x16x32_bf16 v[56:59], v[160:163], v[16:19], v[56:59]
    v_mfma_f32_16x16x32_bf16 v[60:63], v[164:167], v[16:19], v[60:63]
    s_waitcnt vmcnt(8)
    s_barrier
    s_waitcnt lgkmcnt(1)
    v_mfma_f32_16x16x32_bf16 v[64:67], v[160:163], v[20:23], v[64:67]
    ds_read_b128 v[28:31], v4 offset:13312
    v_mfma_f32_16x16x32_bf16 v[68:71], v[164:167], v[20:23], v[68:71]
    ds_read_b128 v[32:35], v4 offset:23552
    s_waitcnt lgkmcnt(2)
    v_mfma_f32_16x16x32_bf16 v[40:43], v[160:163], v[8:11], v[40:43]
    ds_read_b128 v[36:39], v4 offset:33792
    v_mfma_f32_16x16x32_bf16 v[44:47], v[164:167], v[8:11], v[44:47]
    ds_read_b128 v[24:27], v4 offset:3072
    s_waitcnt lgkmcnt(3)
    v_mfma_f32_16x16x32_bf16 v[48:51], v[168:171], v[28:31], v[48:51]
    s_add_u32 m0, s79, 8192
    s_add_u32 s88, s77, 8192
    buffer_load_dwordx4 v1, s[68:71], s88 offen sc1 lds
    v_mfma_f32_16x16x32_bf16 v[52:55], v[172:175], v[28:31], v[52:55]
    s_add_u32 m0, s79, 18432
    s_add_u32 s88, s78, 8192
    buffer_load_dwordx4 v1, s[68:71], s88 offen sc1 lds
    s_waitcnt lgkmcnt(2)
    v_mfma_f32_16x16x32_bf16 v[56:59], v[168:171], v[32:35], v[56:59]
    v_mfma_f32_16x16x32_bf16 v[60:63], v[172:175], v[32:35], v[60:63]
    s_waitcnt vmcnt(8)
    s_barrier
    s_waitcnt lgkmcnt(1)
    v_mfma_f32_16x16x32_bf16 v[64:67], v[168:171], v[36:39], v[64:67]
    ds_read_b128 v[12:15], v4 offset:14336
    v_mfma_f32_16x16x32_bf16 v[68:71], v[172:175], v[36:39], v[68:71]
    ds_read_b128 v[16:19], v4 offset:24576
    s_waitcnt lgkmcnt(2)
    v_mfma_f32_16x16x32_bf16 v[40:43], v[168:171], v[24:27], v[40:43]
    ds_read_b128 v[20:23], v4 offset:34816
    v_mfma_f32_16x16x32_bf16 v[44:47], v[172:175], v[24:27], v[44:47]
    ds_read_b128 v[8:11], v4 offset:4096
    s_waitcnt lgkmcnt(3)
    v_mfma_f32_16x16x32_bf16 v[48:51], v[176:179], v[12:15], v[48:51]
    s_add_u32 m0, s79, 9216
    s_add_u32 s88, s77, 9216
    buffer_load_dwordx4 v1, s[68:71], s88 offen sc1 lds
    v_mfma_f32_16x16x32_bf16 v[52:55], v[180:183], v[12:15], v[52:55]
    s_add_u32 m0, s79, 19456
    s_add_u32 s88, s78, 9216
    buffer_load_dwordx4 v1, s[68:71], s88 offen sc1 lds
    s_waitcnt lgkmcnt(2)
    v_mfma_f32_16x16x32_bf16 v[56:59], v[176:179], v[16:19], v[56:59]
    v_mfma_f32_16x16x32_bf16 v[60:63], v[180:183], v[16:19], v[60:63]
    s_waitcnt vmcnt(8)
    s_barrier
    s_waitcnt lgkmcnt(1)
    v_mfma_f32_16x16x32_bf16 v[64:67], v[176:179], v[20:23], v[64:67]
    ds_read_b128 v[28:31], v4 offset:15360
    v_mfma_f32_16x16x32_bf16 v[68:71], v[180:183], v[20:23], v[68:71]
    ds_read_b128 v[32:35], v4 offset:25600
    s_waitcnt lgkmcnt(2)
    v_mfma_f32_16x16x32_bf16 v[40:43], v[176:179], v[8:11], v[40:43]
    ds_read_b128 v[36:39], v4 offset:35840
    v_mfma_f32_16x16x32_bf16 v[44:47], v[180:183], v[8:11], v[44:47]
    ds_read_b128 v[24:27], v4 offset:5120
    s_waitcnt lgkmcnt(3)
    v_mfma_f32_16x16x32_bf16 v[48:51], v[184:187], v[28:31], v[48:51]
    s_add_u32 m0, s79, 0
    s_add_u32 s88, s77, 10240
    buffer_load_dwordx4 v1, s[68:71], s88 offen sc1 lds
    v_mfma_f32_16x16x32_bf16 v[52:55], v[188:191], v[28:31], v[52:55]
    s_add_u32 m0, s79, 10240
    s_add_u32 s88, s78, 10240
    buffer_load_dwordx4 v1, s[68:71], s88 offen sc1 lds
    s_waitcnt lgkmcnt(2)
    v_mfma_f32_16x16x32_bf16 v[56:59], v[184:187], v[32:35], v[56:59]
    v_mfma_f32_16x16x32_bf16 v[60:63], v[188:191], v[32:35], v[60:63]
    s_waitcnt vmcnt(8)
    s_barrier
    s_waitcnt lgkmcnt(1)
    v_mfma_f32_16x16x32_bf16 v[64:67], v[184:187], v[36:39], v[64:67]
    ds_read_b128 v[12:15], v4 offset:16384
    v_mfma_f32_16x16x32_bf16 v[68:71], v[188:191], v[36:39], v[68:71]
    ds_read_b128 v[16:19], v4 offset:26624
    s_waitcnt lgkmcnt(2)
    v_mfma_f32_16x16x32_bf16 v[40:43], v[184:187], v[24:27], v[40:43]
    ds_read_b128 v[20:23], v4 offset:36864
    v_mfma_f32_16x16x32_bf16 v[44:47], v[188:191], v[24:27], v[44:47]
    ds_read_b128 v[8:11], v4 offset:6144
    s_waitcnt lgkmcnt(3)
    v_mfma_f32_16x16x32_bf16 v[48:51], v[192:195], v[12:15], v[48:51]
    s_add_u32 m0, s79, 1024
    s_add_u32 s88, s77, 11264
    buffer_load_dwordx4 v1, s[68:71], s88 offen sc1 lds
    v_mfma_f32_16x16x32_bf16 v[52:55], v[196:199], v[12:15], v[52:55]
    s_add_u32 m0, s79, 11264
    s_add_u32 s88, s78, 11264
    buffer_load_dwordx4 v1, s[68:71], s88 offen sc1 lds
    s_waitcnt lgkmcnt(2)
    v_mfma_f32_16x16x32_bf16 v[56:59], v[192:195], v[16:19], v[56:59]
    v_mfma_f32_16x16x32_bf16 v[60:63], v[196:199], v[16:19], v[60:63]
    s_waitcnt vmcnt(8)
    s_barrier
    s_waitcnt lgkmcnt(1)
    v_mfma_f32_16x16x32_bf16 v[64:67], v[192:195], v[20:23], v[64:67]
    ds_read_b128 v[28:31], v4 offset:17408
    v_mfma_f32_16x16x32_bf16 v[68:71], v[196:199], v[20:23], v[68:71]
    ds_read_b128 v[32:35], v4 offset:27648
    s_waitcnt lgkmcnt(2)
    v_mfma_f32_16x16x32_bf16 v[40:43], v[192:195], v[8:11], v[40:43]
    ds_read_b128 v[36:39], v4 offset:37888
    v_mfma_f32_16x16x32_bf16 v[44:47], v[196:199], v[8:11], v[44:47]
    ds_read_b128 v[24:27], v4 offset:7168
    s_waitcnt lgkmcnt(3)
    v_mfma_f32_16x16x32_bf16 v[48:51], v[200:203], v[28:31], v[48:51]
    s_add_u32 m0, s79, 2048
    s_add_u32 s88, s77, 12288
    buffer_load_dwordx4 v1, s[68:71], s88 offen sc1 lds
    v_mfma_f32_16x16x32_bf16 v[52:55], v[204:207], v[28:31], v[52:55]
    s_add_u32 m0, s79, 12288
    s_add_u32 s88, s78, 12288
    buffer_load_dwordx4 v1, s[68:71], s88 offen sc1 lds
    s_waitcnt lgkmcnt(2)
    v_mfma_f32_16x16x32_bf16 v[56:59], v[200:203], v[32:35], v[56:59]
    v_mfma_f32_16x16x32_bf16 v[60:63], v[204:207], v[32:35], v[60:63]
    s_waitcnt vmcnt(8)
    s_barrier
    s_waitcnt lgkmcnt(1)
    v_mfma_f32_16x16x32_bf16 v[64:67], v[200:203], v[36:39], v[64:67]
    ds_read_b128 v[12:15], v4 offset:18432
    v_mfma_f32_16x16x32_bf16 v[68:71], v[204:207], v[36:39], v[68:71]
    ds_read_b128 v[16:19], v4 offset:28672
    s_waitcnt lgkmcnt(2)
    v_mfma_f32_16x16x32_bf16 v[40:43], v[200:203], v[24:27], v[40:43]
    ds_read_b128 v[20:23], v4 offset:38912
    v_mfma_f32_16x16x32_bf16 v[44:47], v[204:207], v[24:27], v[44:47]
    ds_read_b128 v[8:11], v4 offset:8192
    s_waitcnt lgkmcnt(3)
    v_mfma_f32_16x16x32_bf16 v[48:51], v[208:211], v[12:15], v[48:51]
    s_add_u32 s88, s76, 59392
    buffer_load_dwordx4 v[232:235], v1, s[60:63], s88 offen offset:0
    v_mfma_f32_16x16x32_bf16 v[52:55], v[212:215], v[12:15], v[52:55]
    buffer_load_dwordx4 v[236:239], v1, s[60:63], s88 offen offset:1024
    s_waitcnt lgkmcnt(2)
    v_mfma_f32_16x16x32_bf16 v[56:59], v[208:211], v[16:19], v[56:59]
    s_add_u32 m0, s79, 3072
    s_add_u32 s88, s77, 13312
    buffer_load_dwordx4 v1, s[72:75], s88 offen sc1 lds
    v_mfma_f32_16x16x32_bf16 v[60:63], v[212:215], v[16:19], v[60:63]
    s_add_u32 m0, s79, 13312
    s_add_u32 s88, s78, 13312
    buffer_load_dwordx4 v1, s[72:75], s88 offen sc1 lds
    s_waitcnt vmcnt(10)
    s_barrier
    s_waitcnt lgkmcnt(1)
    v_mfma_f32_16x16x32_bf16 v[64:67], v[208:211], v[20:23], v[64:67]
    ds_read_b128 v[28:31], v4 offset:19456
    v_mfma_f32_16x16x32_bf16 v[68:71], v[212:215], v[20:23], v[68:71]
    ds_read_b128 v[32:35], v4 offset:29696
    s_waitcnt lgkmcnt(2)
    v_mfma_f32_16x16x32_bf16 v[40:43], v[208:211], v[8:11], v[40:43]
    ds_read_b128 v[36:39], v4 offset:39936
    v_mfma_f32_16x16x32_bf16 v[44:47], v[212:215], v[8:11], v[44:47]
    ds_read_b128 v[24:27], v4 offset:9216
    s_waitcnt lgkmcnt(3)
    v_mfma_f32_16x16x32_bf16 v[48:51], v[216:219], v[28:31], v[48:51]
    s_add_u32 s88, s76, 64512
    buffer_load_dwordx4 v[240:243], v1, s[60:63], s88 offen offset:0
    v_mfma_f32_16x16x32_bf16 v[52:55], v[220:223], v[28:31], v[52:55]
    buffer_load_dwordx4 v[244:247], v1, s[60:63], s88 offen offset:1024
    s_waitcnt lgkmcnt(2)
    v_mfma_f32_16x16x32_bf16 v[56:59], v[216:219], v[32:35], v[56:59]
    v_mfma_f32_16x16x32_bf16 v[60:63], v[220:223], v[32:35], v[60:63]
    s_waitcnt vmcnt(10)
    s_barrier
    s_waitcnt lgkmcnt(1)
    v_mfma_f32_16x16x32_bf16 v[64:67], v[216:219], v[36:39], v[64:67]
    ds_read_b128 v[12:15], v4 offset:10240
    v_mfma_f32_16x16x32_bf16 v[68:71], v[220:223], v[36:39], v[68:71]
    ds_read_b128 v[16:19], v4 offset:20480
    s_waitcnt lgkmcnt(2)
    v_mfma_f32_16x16x32_bf16 v[40:43], v[216:219], v[24:27], v[40:43]
    ds_read_b128 v[20:23], v4 offset:30720
    v_mfma_f32_16x16x32_bf16 v[44:47], v[220:223], v[24:27], v[44:47]
    ds_read_b128 v[8:11], v4 offset:0
    s_waitcnt lgkmcnt(3)
    v_mfma_f32_16x16x32_bf16 v[48:51], v[224:227], v[12:15], v[48:51]
    s_add_u32 s88, s76, 69632
    buffer_load_dwordx4 v[248:251], v1, s[64:67], s88 offen offset:0
    v_mfma_f32_16x16x32_bf16 v[52:55], v[228:231], v[12:15], v[52:55]
    buffer_load_dwordx4 v[252:255], v1, s[64:67], s88 offen offset:1024
    s_waitcnt lgkmcnt(2)
    v_mfma_f32_16x16x32_bf16 v[56:59], v[224:227], v[16:19], v[56:59]
    v_mfma_f32_16x16x32_bf16 v[60:63], v[228:231], v[16:19], v[60:63]
    s_waitcnt vmcnt(10)
    s_barrier
    s_waitcnt lgkmcnt(1)
    v_mfma_f32_16x16x32_bf16 v[64:67], v[224:227], v[20:23], v[64:67]
    ds_read_b128 v[28:31], v4 offset:11264
    v_mfma_f32_16x16x32_bf16 v[68:71], v[228:231], v[20:23], v[68:71]
    ds_read_b128 v[32:35], v4 offset:21504
    s_waitcnt lgkmcnt(2)
    v_mfma_f32_16x16x32_bf16 v[40:43], v[224:227], v[8:11], v[40:43]
    ds_read_b128 v[36:39], v4 offset:31744
    v_mfma_f32_16x16x32_bf16 v[44:47], v[228:231], v[8:11], v[44:47]
    ds_read_b128 v[24:27], v4 offset:1024
    s_waitcnt vmcnt(6)
    s_waitcnt lgkmcnt(3)
    v_mfma_f32_16x16x32_bf16 v[48:51], v[232:235], v[28:31], v[48:51]
    buffer_load_dwordx4 v[144:147], v3, s[32:35], s23 offen offset:0
    v_mfma_f32_16x16x32_bf16 v[52:55], v[236:239], v[28:31], v[52:55]
    buffer_load_dwordx4 v[148:151], v3, s[32:35], s23 offen offset:64
    s_waitcnt lgkmcnt(2)
    v_mfma_f32_16x16x32_bf16 v[56:59], v[232:235], v[32:35], v[56:59]
    s_add_u32 m0, s26, 36864
    s_add_u32 s88, s22, 0
    buffer_load_dwordx4 v2, s[28:31], s88 offen lds
    v_mfma_f32_16x16x32_bf16 v[60:63], v[236:239], v[32:35], v[60:63]
    s_waitcnt vmcnt(11)
    s_barrier
    s_waitcnt lgkmcnt(1)
    v_mfma_f32_16x16x32_bf16 v[64:67], v[232:235], v[36:39], v[64:67]
    ds_read_b128 v[12:15], v4 offset:12288
    v_mfma_f32_16x16x32_bf16 v[68:71], v[236:239], v[36:39], v[68:71]
    ds_read_b128 v[16:19], v4 offset:22528
    s_waitcnt lgkmcnt(2)
    v_mfma_f32_16x16x32_bf16 v[40:43], v[232:235], v[24:27], v[40:43]
    ds_read_b128 v[20:23], v4 offset:32768
    v_mfma_f32_16x16x32_bf16 v[44:47], v[236:239], v[24:27], v[44:47]
    ds_read_b128 v[8:11], v4 offset:2048
    s_waitcnt vmcnt(5)
    s_waitcnt lgkmcnt(3)
    v_mfma_f32_16x16x32_bf16 v[48:51], v[240:243], v[12:15], v[48:51]
    v_mfma_f32_16x16x32_bf16 v[52:55], v[244:247], v[12:15], v[52:55]
    s_waitcnt lgkmcnt(2)
    v_mfma_f32_16x16x32_bf16 v[56:59], v[240:243], v[16:19], v[56:59]
    v_mfma_f32_16x16x32_bf16 v[60:63], v[244:247], v[16:19], v[60:63]
    s_waitcnt vmcnt(7)
    s_barrier
    s_waitcnt lgkmcnt(1)
    v_mfma_f32_16x16x32_bf16 v[64:67], v[240:243], v[20:23], v[64:67]
    ds_read_b128 v[28:31], v4 offset:13312
    v_mfma_f32_16x16x32_bf16 v[68:71], v[244:247], v[20:23], v[68:71]
    ds_read_b128 v[32:35], v4 offset:23552
    s_waitcnt lgkmcnt(2)
    v_mfma_f32_16x16x32_bf16 v[40:43], v[240:243], v[8:11], v[40:43]
    ds_read_b128 v[36:39], v4 offset:33792
    v_mfma_f32_16x16x32_bf16 v[44:47], v[244:247], v[8:11], v[44:47]
    ds_read_b128 v[24:27], v4 offset:3072
    s_waitcnt vmcnt(3)
    s_nop 3
    s_add_u32 s88, s54, 1
    s_and_b32 s88, s88, 3
    s_mul_i32 s88, s88, 40960
    v_add_u32 v13, s88, v1
    s_add_u32 s88, s54, 2
    s_and_b32 s88, s88, 3
    s_mul_i32 s88, s88, 40960
    v_add_u32 v14, s88, v1
    s_add_u32 s88, s54, 3
    s_and_b32 s88, s88, 3
    s_mul_i32 s88, s88, 40960
    v_add_u32 v15, s88, v1
    s_cmp_ge_u32 s54, 2
    s_cbranch_scc1 p2_skip2
    s_waitcnt lgkmcnt(3)
    v_mfma_f32_16x16x32_bf16 v[48:51], v[248:251], v[28:31], v[48:51]
    v_mfma_f32_16x16x32_bf16 v[52:55], v[252:255], v[28:31], v[52:55]
    s_waitcnt lgkmcnt(2)
    v_mfma_f32_16x16x32_bf16 v[56:59], v[248:251], v[32:35], v[56:59]
    v_mfma_f32_16x16x32_bf16 v[60:63], v[252:255], v[32:35], v[60:63]
    s_waitcnt lgkmcnt(1)
    v_mfma_f32_16x16x32_bf16 v[64:67], v[248:251], v[36:39], v[64:67]
    v_mfma_f32_16x16x32_bf16 v[68:71], v[252:255], v[36:39], v[68:71]
    ds_write_b128 v13, v[48:51] offset:7168
    ds_write_b128 v13, v[52:55] offset:8192
    s_waitcnt lgkmcnt(2)
    v_mfma_f32_16x16x32_bf16 v[40:43], v[248:251], v[24:27], v[40:43]
    v_mfma_f32_16x16x32_bf16 v[44:47], v[252:255], v[24:27], v[44:47]
    ds_write_b128 v14, v[56:59] offset:17408
    ds_write_b128 v14, v[60:63] offset:18432
    s_branch p2_w2
p2_skip2:
    ds_write_b128 v13, v[48:51] offset:7168
    ds_write_b128 v13, v[52:55] offset:8192
    ds_write_b128 v14, v[56:59] offset:17408
    ds_write_b128 v14, v[60:63] offset:18432
p2_w2:
    s_nop 3
    ds_write_b128 v15, v[64:67] offset:27648
    ds_write_b128 v15, v[68:71] offset:28672
    s_mov_b32 s43, 0xffff0000
    s_waitcnt vmcnt(0)
    ds_read_b64_tr_b16 v[152:153], v5 offset:36864
    ds_read_b64_tr_b16 v[156:157], v5 offset:37376
    s_waitcnt lgkmcnt(0)
    s_barrier
    ds_read_b128 v[48:51], v4 offset:7168
    ds_read_b128 v[56:59], v4 offset:17408
    ds_read_b128 v[64:67], v4 offset:27648
    ds_read_b128 v[52:55], v4 offset:8192
    ds_read_b128 v[60:63], v4 offset:18432
    ds_read_b128 v[68:71], v4 offset:28672
    s_waitcnt vmcnt(0)
    v_and_b32 v155, s43, v153
    v_lshlrev_b32 v154, 16, v153
    v_and_b32 v153, s43, v152
    v_lshlrev_b32 v152, 16, v152
    v_and_b32 v159, s43, v157
    v_lshlrev_b32 v158, 16, v157
    v_and_b32 v157, s43, v156
    v_lshlrev_b32 v156, 16, v156
    s_waitcnt lgkmcnt(3)
    v_pk_add_f32 v[40:41], v[40:41], v[48:49]
    v_pk_add_f32 v[42:43], v[42:43], v[50:51]
    v_pk_add_f32 v[56:57], v[56:57], v[64:65]
    v_pk_add_f32 v[58:59], v[58:59], v[66:67]
    v_pk_add_f32 v[40:41], v[40:41], v[56:57]
    v_pk_add_f32 v[42:43], v[42:43], v[58:59]
    v_cvt_pk_bf16_f32 v40, v40, v41
    v_cvt_pk_bf16_f32 v42, v42, v43
    v_and_b32 v41, s43, v40
    v_and_b32 v43, s43, v42
    v_lshlrev_b32 v40, 16, v40
    v_lshlrev_b32 v42, 16, v42
    v_pk_mul_f32 v[40:41], v[40:41], v[144:145]
    v_pk_mul_f32 v[42:43], v[42:43], v[146:147]
    v_cvt_pk_bf16_f32 v40, v40, v41
    v_cvt_pk_bf16_f32 v42, v42, v43
    v_and_b32 v41, s43, v40
    v_and_b32 v43, s43, v42
    v_lshlrev_b32 v40, 16, v40
    v_lshlrev_b32 v42, 16, v42
    v_pk_add_f32 v[40:41], v[40:41], v[152:153]
    v_pk_add_f32 v[42:43], v[42:43], v[154:155]
    v_cvt_pk_bf16_f32 v8, v40, v41
    v_cvt_pk_bf16_f32 v9, v42, v43
    s_waitcnt lgkmcnt(0)
    v_pk_add_f32 v[44:45], v[44:45], v[52:53]
    v_pk_add_f32 v[46:47], v[46:47], v[54:55]
    v_pk_add_f32 v[60:61], v[60:61], v[68:69]
    v_pk_add_f32 v[62:63], v[62:63], v[70:71]
    v_pk_add_f32 v[44:45], v[44:45], v[60:61]
    v_pk_add_f32 v[46:47], v[46:47], v[62:63]
    v_cvt_pk_bf16_f32 v44, v44, v45
    v_cvt_pk_bf16_f32 v46, v46, v47
    v_and_b32 v45, s43, v44
    v_and_b32 v47, s43, v46
    v_lshlrev_b32 v44, 16, v44
    v_lshlrev_b32 v46, 16, v46
    v_pk_mul_f32 v[44:45], v[44:45], v[148:149]
    v_pk_mul_f32 v[46:47], v[46:47], v[150:151]
    v_cvt_pk_bf16_f32 v44, v44, v45
    v_cvt_pk_bf16_f32 v46, v46, v47
    v_and_b32 v45, s43, v44
    v_and_b32 v47, s43, v46
    v_lshlrev_b32 v44, 16, v44
    v_lshlrev_b32 v46, 16, v46
    v_pk_add_f32 v[44:45], v[44:45], v[156:157]
    v_pk_add_f32 v[46:47], v[46:47], v[158:159]
    v_cvt_pk_bf16_f32 v10, v44, v45
    v_cvt_pk_bf16_f32 v11, v46, v47
    s_nop 1
    v_permlane32_swap_b32 v8, v10
    v_permlane32_swap_b32 v9, v11
    s_nop 1
    v_permlane16_swap_b32 v8, v10
    v_permlane16_swap_b32 v9, v11
    s_nop 1
    buffer_store_dwordx4 v[8:11], v6, s[36:39], s24 offen
    s_endpgm
g1_done:
    s_endpgm
g12_end:
.section .rodata,"a"
.p2align 6
.amdhsa_kernel g12_kernel
  .amdhsa_next_free_vgpr 256
  .amdhsa_next_free_sgpr 100
  .amdhsa_accum_offset 256
  .amdhsa_group_segment_fixed_size 0
  .amdhsa_kernarg_size 136
  .amdhsa_user_sgpr_count 2
  .amdhsa_user_sgpr_kernarg_segment_ptr 1
  .amdhsa_system_sgpr_workgroup_id_x 1
.end_amdhsa_kernel
.text
```
